```python
import torch

def _softmax(x, axis=-1):
    return torch.softmax(x, dim=axis)
def _gelu(x):
    return torch.nn.functional.gelu(x, approximate="tanh")
def _silu(x):
    return torch.nn.functional.silu(x)
def _sigmoid(x):
    return torch.sigmoid(x)
def _layernorm(x, axis=-1, eps=1e-5):
    m = x.mean(dim=axis, keepdim=True)
    v = x.var(dim=axis, keepdim=True, unbiased=False)
    return (x - m) / torch.sqrt(v + eps)
def _scatter_add(tgt, idx, src, axis=0):
    return tgt.clone().index_add_(axis, idx, src)
def _segment_sum(src, seg, n):
    out = torch.zeros((n,) + src.shape[1:], dtype=src.dtype)
    return out.index_add_(0, seg, src)
def _pad(x, pw):
    flat = tuple(v for pair in reversed(pw) for v in pair)
    return torch.nn.functional.pad(x, flat)

kernel_name = 'gated_mix__linear_kernel_hedgehog__sliding_block__prompt'

def setup_inputs():

    _w = (lambda a: (lambda t: t.to(torch.bfloat16) if t.is_floating_point() else t)(torch.as_tensor(a)))
    def _A_setup():
        B, S, D, H = 1, 2048, 512, 32
        Dh = D // H
        return {
            "x": _w((lambda *s: torch.randn(*s, dtype=torch.bfloat16) * 0.05)(B, S, D)),
            "wqkv": _w((lambda *s: torch.randn(*s, dtype=torch.bfloat16) * 1.6)(D, 3 * D)),
            "w_phi": _w((lambda *s: torch.randn(*s, dtype=torch.bfloat16) * 1.6)(H, Dh, Dh) * (Dh ** -0.5)),
            "wo": _w((lambda *s: torch.randn(*s, dtype=torch.bfloat16) * 0.1)(D, D)),
        }
    _A_in = _A_setup()

    def _B_setup():
        B, S, D = 1, 2048, 512
        return {
            "x": _w((lambda *s: torch.randn(*s, dtype=torch.bfloat16) * 0.05)(B, S, D)),
            "wqkv": _w((lambda *s: torch.randn(*s, dtype=torch.bfloat16) * 0.8)(D, 3 * D)),
            "wo": _w((lambda *s: torch.randn(*s, dtype=torch.bfloat16) * 0.05)(D, D)),
        }
    _B_in = _B_setup()

    return {
        "A_x": _A_in["x"],
        "A_wqkv": _A_in["wqkv"],
        "A_w_phi": _A_in["w_phi"],
        "A_wo": _A_in["wo"],
        "B_x": _B_in["x"],
        "B_wqkv": _B_in["wqkv"],
        "B_wo": _B_in["wo"],
        "gate_w": _w((lambda *s: torch.randn(*s, dtype=torch.bfloat16) * 0.05)(512) * 16.0),
    }

def reference(A_x, A_wqkv, A_w_phi, A_wo, B_x, B_wqkv, B_wo, gate_w):
    def _A_ref(x, wqkv, w_phi, wo):
        B, S, D = x.shape
        H = 32; Dh = D // H
        qkv = (lambda x, *d: x.permute(*d))((x @ wqkv).reshape(B, S, 3, H, Dh), 2, 0, 3, 1, 4)
        q, k, v = qkv[0], qkv[1], qkv[2]
        pq = torch.einsum("bhsd,hdf->bhsf", q, w_phi)
        pk = torch.einsum("bhsd,hdf->bhsf", k, w_phi)
        phi_q = torch.concatenate([_softmax(pq, axis=-1), _softmax(-pq, axis=-1)], axis=-1)
        phi_k = torch.concatenate([_softmax(pk, axis=-1), _softmax(-pk, axis=-1)], axis=-1)
        kv = torch.einsum("bhsf,bhsd->bhfd", phi_k, v)
        z  = torch.einsum("bhsf->bhf", phi_k)
        num = torch.einsum("bhqf,bhfd->bhqd", phi_q, kv)
        den = torch.einsum("bhqf,bhf->bhq", phi_q, z)[..., None] + 1e-6
        o = num / den
        return (lambda x, *d: x.permute(*d))(o, 0, 2, 1, 3).reshape(B, S, D) @ wo

    def _B_ref(x, wqkv, wo):
        B, S, D = x.shape
        H = 32; Dh = D // H; W = 256
        qkv = (lambda x, *d: x.permute(*d))((x @ wqkv).reshape(B, S, 3, H, Dh), 2, 0, 3, 1, 4)
        q, k, v = qkv[0], qkv[1], qkv[2]
        scores = torch.einsum("bhqd,bhkd->bhqk", q, k) * (Dh ** -0.5)
        idx = torch.arange(S)
        mask = (idx[:, None] - idx[None, :] >= 0) & (idx[:, None] - idx[None, :] < W)
        scores = torch.where(mask[None, None], scores, -1e9)
        p = _softmax(scores, axis=-1)
        o = torch.einsum("bhqk,bhkd->bhqd", p, v)
        return (lambda x, *d: x.permute(*d))(o, 0, 2, 1, 3).reshape(B, S, D) @ wo

    x = A_x
    g = _sigmoid((x * gate_w).sum(-1, keepdims=True))
    a = _A_ref(x, A_wqkv, A_w_phi, A_wo)
    b = _B_ref(x, B_wqkv, B_wo)
    return g * a + (1 - g) * b
```

```asm
; @launch grid=(256,1,1) block=(512,1,1) lds=163840
.amdgcn_target "amdgcn-amd-amdhsa--gfx950"
.text
.globl gated_mix__linear_kernel_hedgehog__sliding_block__prompt_kernel
.p2align 8
.type gated_mix__linear_kernel_hedgehog__sliding_block__prompt_kernel,@function
gated_mix__linear_kernel_hedgehog__sliding_block__prompt_kernel:
    s_cmp_ge_u32 s2, 256
    s_cbranch_scc1 L_exit
    s_load_dwordx4 s[64:67], s[0:1], 0
    s_load_dwordx4 s[72:75], s[0:1], 40
    s_load_dwordx4 s[84:87], s[0:1], 16
    s_load_dwordx4 s[76:79], s[0:1], 56
    s_load_dwordx2 s[80:81], s[0:1], 80
    v_lshrrev_b32 v48, 6, v0
    v_and_b32 v1, 63, v0
    s_lshr_b32 s50, s2, 3
    v_readfirstlane_b32 s40, v48
    s_getpc_b64 s[58:59]
L_pc:
    s_sub_u32 s28, s58, L_pc-gated_mix__linear_kernel_hedgehog__sliding_block__prompt_kernel
    s_subb_u32 s29, s59, 0
    s_and_b32 s29, s29, 0xffff
    s_mov_b32 s30, L_codeend-gated_mix__linear_kernel_hedgehog__sliding_block__prompt_kernel
    s_mov_b32 s31, 0x20000
    s_cmp_eq_u32 s40, 7
    s_cbranch_scc0 Lskip_1
    v_min_u32 v51, 4, v1
    v_lshlrev_b32 v51, 7, v51
    s_mul_i32 s51, s50, 640
    buffer_load_dword v127, v51, s[28:31], s51 offen
Lskip_1:
    s_and_b32 s44, s2, 1
    s_lshl_b32 s44, s44, 4
    s_and_b32 s51, s50, 15
    s_add_u32 s44, s44, s51
    s_and_b32 s43, s2, 6
    s_lshr_b32 s51, s50, 4
    s_add_u32 s43, s43, s51
    s_and_b32 s70, s44, 1
    s_lshr_b32 s71, s44, 1
    s_lshl_b32 s45, s51, 1
    s_add_u32 s45, s45, s70
    s_lshl_b32 s45, s45, 1
    s_add_u32 s45, s45, s71
    s_lshr_b32 s51, s43, 1
    s_add_u32 s45, s45, s51
    s_and_b32 s45, s45, 7
    s_lshl_b32 s47, s40, 10
    v_lshlrev_b32 v2, 4, v1
    s_lshl_b32 s63, s40, 11
    v_lshrrev_b32 v48, 3, v0
    v_and_b32 v49, 7, v1
    v_bfe_u32 v50, v1, 4, 1
    v_and_b32 v51, 6, v48
    v_xor_b32 v51, v51, v49
    v_lshlrev_b32 v51, 4, v51
    s_lshl_b32 s51, s70, 5
    v_xor_b32 v52, s51, v48
    s_lshl_b32 s51, s71, 6
    v_add_u32 v52, s51, v52
    v_lshl_add_u32 v3, v52, 11, v51
    v_xor_b32 v125, 16, v3
    v_lshlrev_b32 v51, 1, v50
    v_xor_b32 v51, v51, v49
    v_lshlrev_b32 v51, 4, v51
    v_and_b32 v52, 64, v0
    v_xor_b32 v51, v51, v52
    v_mul_u32_u24 v52, 3072, v48
    s_lshl_b32 s51, s43, 7
    v_add3_u32 v4, v52, v51, s51
    s_mul_i32 s32, s45, 196608
    s_lshl_b32 s52, s45, 7
    v_add_u32 v53, s52, v2
    v_and_b32 v53, 1023, v53
    s_waitcnt lgkmcnt(0)
    s_mov_b32 s4, s64
    s_and_b32 s5, s65, 0xffff
    s_mov_b32 s6, 2097152
    s_mov_b32 s7, 0x20000
    s_add_u32 m0, s63, 2048
    s_nop 0
    buffer_load_dwordx4 v3, s[4:7], s52 offen offset:0 lds
    buffer_load_dwordx4 v125, s[4:7], s52 offen offset:1024 lds
    s_cmp_eq_u32 s70, 1
    s_cselect_b32 s92, s66, s72
    s_cselect_b32 s93, s67, s73
    s_and_b32 s93, s93, 0xffff
    s_mov_b32 s94, 1572864
    s_mov_b32 s95, 0x20000
    s_add_u32 m0, s63, 17408
    s_nop 0
    buffer_load_dwordx4 v4, s[92:95], s32 offen offset:1024 lds
    buffer_load_dwordx4 v4, s[92:95], s32 offen offset:2048 lds
    s_load_dword s82, s[80:81], 0
    s_mov_b32 s20, s84
    s_and_b32 s21, s85, 0xffff
    s_mov_b32 s22, 16384
    s_mov_b32 s23, 0x20000
    s_mov_b32 s24, s76
    s_and_b32 s25, s77, 0xffff
    s_mov_b32 s26, 1024
    s_mov_b32 s27, 0x20000
    s_cmp_lt_u32 s40, 2
    s_cbranch_scc0 Lskip_2
    s_lshl_b32 s50, s43, 11
    s_add_u32 m0, s47, 0
    s_add_u32 s50, s50, s47
    buffer_load_dwordx4 v2, s[20:23], s50 offen lds
Lskip_2:
    s_cmp_eq_u32 s40, 2
    s_cbranch_scc0 Lskip_3
    s_mov_b32 m0, 149504
    s_nop 0
    buffer_load_dwordx4 v53, s[24:27], 0 offen lds
Lskip_3:
    s_sub_u32 s72, s72, 1024
    s_subb_u32 s73, s73, 0
    s_and_b32 s41, s40, 1
    s_lshr_b32 s42, s40, 1
    s_lshr_b32 s50, s2, 3
    s_and_b32 s54, s2, 7
    s_lshl_b32 s54, s54, 2
    s_lshr_b32 s51, s50, 3
    s_add_u32 s54, s54, s51
    s_and_b32 s55, s50, 7
    s_add_u32 s53, s42, s55
    s_and_b32 s53, s53, 3
    s_cmp_eq_u32 s40, 3
    s_cbranch_scc0 Lskip_4
    v_mov_b32 v96, 0x3f80
    v_mov_b32 v97, 0
    v_mov_b32 v98, 0x3f80
    v_mov_b32 v99, 0
    v_add_u32 v100, 151552, v2
    ds_write_b128 v100, v[96:99]
Lskip_4:
    v_and_b32 v54, 31, v1
    s_mov_b32 s8, s66
    v_lshrrev_b32 v55, 5, v1
    s_and_b32 s9, s67, 0xffff
    v_bfe_u32 v56, v1, 2, 2
    s_mov_b32 s10, 1572864
    v_and_b32 v57, 3, v1
    s_mov_b32 s11, 0x20000
    v_lshlrev_b32 v24, 7, v1
    s_mov_b32 s12, s72
    s_lshl_b32 s51, s41, 5
    v_add_u32 v48, s51, v54
    s_and_b32 s13, s73, 0xffff
    v_and_b32 v49, 1, v1
    s_mov_b32 s14, 1573888
    v_lshl_or_b32 v51, v56, 1, v49
    s_mov_b32 s15, 0x20000
    v_lshrrev_b32 v52, 4, v1
    s_mov_b32 s20, s86
    v_xor_b32 v51, v51, v52
    s_and_b32 s21, s87, 0xffff
    v_lshlrev_b32 v51, 4, v51
    s_mov_b32 s22, 524288
    v_lshl_add_u32 v51, v49, 10, v51
    s_mov_b32 s23, 0x20000
    v_bfe_u32 v49, v1, 1, 3
    s_mov_b32 s24, s74
    v_lshl_add_u32 v51, v49, 7, v51
    s_and_b32 s25, s75, 0xffff
    s_lshl_b32 s51, s41, 12
    v_add_u32 v8, s51, v51
    s_mov_b32 s26, 524288
    v_xor_b32 v9, 64, v8
    s_mov_b32 s27, 0x20000
    s_lshl_b32 s51, s41, 6
    v_xor_b32 v53, s51, v51
    s_mov_b32 s16, s80
    s_lshl_b32 s51, s42, 11
    v_add_u32 v120, s51, v53
    s_and_b32 s17, s81, 0xffff
    s_lshl_b32 s51, s41, 2
    v_or_b32 v49, s51, v52
    s_mov_b32 s18, 16777216
    v_and_b32 v53, 7, v1
    s_mov_b32 s19, 0x20000
    v_lshlrev_b32 v53, 7, v53
    s_mov_b32 s28, s78
    v_lshl_add_u32 v53, v49, 4, v53
    s_and_b32 s29, s79, 0xffff
    v_add_u32 v121, 149504, v53
    s_mov_b32 s30, 2097152
    v_lshrrev_b32 v51, 1, v56
    s_mov_b32 s31, 0x20000
    v_lshl_add_u32 v51, v50, 1, v51
    s_add_u32 s33, s45, 1
    v_xor_b32 v51, s42, v51
    s_and_b32 s33, s33, 7
    v_lshlrev_b32 v51, 5, v51
    s_mul_i32 s33, s33, 196608
    v_lshl_add_u32 v53, v52, 4, v56
    s_add_u32 s34, s45, 2
    v_lshlrev_b32 v53, 7, v53
    s_and_b32 s34, s34, 7
    v_lshl_add_u32 v53, v57, 3, v53
    s_lshl_b32 s76, s34, 7
    v_add_u32 v124, v51, v53
    s_mul_i32 s34, s34, 196608
    v_add_u32 v6, 83968, v124
    s_add_u32 s35, s45, 3
    v_lshrrev_b32 v52, 1, v57
    s_and_b32 s35, s35, 7
    v_lshl_add_u32 v49, v55, 3, v56
    s_lshl_b32 s77, s35, 7
    v_lshlrev_b32 v122, 5, v49
    s_mul_i32 s35, s35, 196608
    v_lshl_add_u32 v122, v50, 4, v122
    s_add_u32 s36, s45, 4
    v_lshl_add_u32 v122, v52, 3, v122
    s_and_b32 s36, s36, 7
    s_lshl_b32 s51, s42, 9
    v_add_u32 v122, s51, v122
    s_lshl_b32 s78, s36, 7
    v_bfe_u32 v123, v1, 2, 1
    s_mul_i32 s36, s36, 196608
    v_mul_u32_u24 v123, 0x8000, v123
    s_add_u32 s37, s45, 5
    v_lshl_or_b32 v123, v123, 16, v123
    s_and_b32 s37, s37, 7
    v_and_b32 v49, 1, v56
    s_lshl_b32 s79, s37, 7
    v_mul_u32_u24 v51, 1088, v49
    s_mul_i32 s37, s37, 196608
    v_lshrrev_b32 v49, 1, v56
    s_add_u32 s38, s45, 6
    v_lshl_add_u32 v49, v55, 2, v49
    s_and_b32 s38, s38, 7
    v_lshl_add_u32 v51, v49, 7, v51
    s_lshl_b32 s80, s38, 7
    v_lshl_add_u32 v51, v50, 5, v51
    s_mul_i32 s38, s38, 196608
    v_lshl_add_u32 v51, v57, 3, v51
    s_add_u32 s39, s45, 7
    s_sub_u32 s51, s53, s54
    s_and_b32 s51, s51, 3
    s_lshl_b32 s51, s51, 14
    s_add_u32 s51, s51, 83968
    v_add_u32 v249, s51, v51
    s_and_b32 s39, s39, 7
    v_xor_b32 v250, 64, v249
    s_lshl_b32 s81, s39, 7
    v_lshlrev_b32 v28, 2, v48
    s_mul_i32 s39, s39, 196608
    v_add_u32 v28, 150528, v28
    s_lshl_b32 s48, s44, 1
    s_lshl_b32 s51, s41, 9
    s_lshl_b32 s52, s42, 6
    s_add_u32 s51, s51, s52
    s_add_u32 s51, s51, 150528
    v_and_b32 v49, 15, v1
    s_add_u32 s48, s48, s41
    v_lshl_add_u32 v49, v49, 2, s51
    s_lshl_b32 s50, s43, 5
    v_lshl_add_u32 v31, v50, 8, v49
    s_lshl_b32 s1, s40, 2
    s_mul_i32 s51, s40, 1152
    s_add_u32 s51, s51, 152576
    v_add_u32 v25, s51, v2
    s_add_u32 s1, s1, s50
    v_lshl_add_u32 v25, v55, 6, v25
    s_lshl_b32 s83, s1, 6
    v_lshrrev_b32 v49, 4, v1
    s_add_u32 s84, s83, 131072
    v_lshl_add_u32 v53, v49, 3, v56
    s_add_u32 s83, s83, 65536
    v_and_b32 v57, 1, v57
    s_mul_i32 s60, s1, 5120
    v_lshlrev_b32 v57, 3, v57
    s_mul_i32 s1, s71, 320
    v_lshl_add_u32 v51, v53, 4, v57
    s_add_u32 s60, s60, s1
    s_mul_i32 s51, s42, 2304
    s_add_u32 s51, s51, 152576
    v_mul_u32_u24 v53, 71, v57
    s_add_u32 s60, s60, 1048576
    v_lshl_add_u32 v53, v52, 3, v53
    s_lshl_b32 s1, s71, 1
    v_add3_u32 v27, v53, v51, s51
    s_add_u32 s1, s1, s50
    s_lshl_b32 s51, s41, 9
    s_lshl_b32 s52, s42, 11
    s_add_u32 s51, s51, s52
    s_add_u32 s51, s51, 67584
    v_lshl_add_u32 v51, v52, 10, v51
    s_lshl_b32 s3, s1, 8
    v_add_u32 v26, s51, v51
    s_add_u32 s3, s3, 262144
    v_mul_u32_u24 v49, 5120, v49
    s_lshl_b32 s1, s1, 6
    v_and_b32 v51, 15, v1
    s_add_u32 s85, s1, 130816
    v_lshl_add_u32 v30, v51, 4, v49
    s_lshl_b32 s0, s70, 16
    s_lshl_b32 s51, s41, 13
    s_add_u32 s51, s51, s52
    s_add_u32 s52, s51, 2048
    v_add_u32 v244, s52, v2
    s_sub_u32 s62, s1, s0
    v_add_u32 v29, 65536, v244
    s_add_u32 s62, s62, 131072
    s_lshl_b32 s61, s43, 19
    s_add_u32 s61, s61, s51
    s_lshl_b32 s51, s44, 14
    s_add_u32 s61, s61, s51
    s_add_u32 s61, s61, 5242880
    v_lshrrev_b32 v53, 3, v57
    s_min_u32 s0, s71, 2
    v_xor_b32 v49, v55, v53
    s_sub_u32 s0, 2, s0
    v_lshl_add_u32 v49, v49, 2, v56
    s_lshl_b32 s90, 7, s0
    v_lshlrev_b32 v49, 4, v49
    s_and_b32 s90, s90, 7
    v_lshl_add_u32 v49, v52, 3, v49
    s_mov_b32 s91, 0
    v_lshl_add_u32 v49, v53, 9, v49
    s_lshl_b32 s0, s42, 3
    s_add_u32 s52, s52, 1024
    v_add_u32 v49, s52, v49
    s_add_u32 s0, s0, s50
    v_cmp_eq_u32 s[58:59], 1, v50
    s_lshl_b32 s87, s0, 8
    v_mov_b32 v51, 151680
    s_add_u32 s87, s87, 262144
    v_mov_b32 v53, 8192
    s_lshl_b32 s49, s44, 3
    v_min_u32 v52, 16, v54
    s_add_u32 s49, s49, s43
    v_cndmask_b32 v247, v49, v51, s[58:59]
    s_lshl_b32 s49, s49, 7
    v_cndmask_b32 v246, v53, 0, s[58:59]
    s_add_u32 s49, s49, 196608
    v_lshl_add_u32 v245, v246, 3, v247
    s_lshl_b32 s88, s54, 10
    v_lshlrev_b32 v51, 3, v52
    s_lshl_b32 s0, s53, 8
    v_lshl_add_u32 v248, v55, 10, v51
    s_add_u32 s88, s88, s0
    s_add_u32 s51, s63, 133120
    v_add_u32 v51, s51, v2
    s_add_u32 s88, s88, 196608
    ds_write_b128 v51, v[244:247]
    s_lshl_b32 s50, s41, 15
    ds_write_b128 v51, v[248:251] offset:1024
    s_add_u32 s50, s50, 9437184
    v_lshlrev_b32 v49, 2, v55
    s_lshl_b32 s56, s44, 17
    v_sub_u32 v49, v49, v54
    s_add_u32 s56, s56, s50
    v_add_u32 v53, -1, v49
    s_lshl_b32 s1, s43, 2
    v_and_b32 v53, 0xffff, v53
    s_add_u32 s1, s1, s42
    v_lshl_or_b32 v49, v49, 16, v53
    s_lshl_b32 s1, s1, 10
    v_pk_add_i16 v16, v49, 0 op_sel_hi:[1,0]
    s_add_u32 s56, s56, s1
    v_pk_add_i16 v17, v49, 2 op_sel_hi:[1,0]
    s_add_u32 s57, s56, 65536
    v_pk_add_i16 v18, v49, 8 op_sel_hi:[1,0]
    s_lshl_b32 s72, s54, 17
    v_pk_add_i16 v19, v49, 10 op_sel_hi:[1,0]
    s_add_u32 s72, s72, s50
    v_pk_add_i16 v20, v49, 16 op_sel_hi:[1,0]
    s_lshl_b32 s1, s53, 13
    v_pk_add_i16 v21, v49, 18 op_sel_hi:[1,0]
    s_add_u32 s72, s72, s1
    v_pk_add_i16 v22, v49, 24 op_sel_hi:[1,0]
    s_and_b32 s50, s55, 4
    v_pk_add_i16 v23, v49, 26 op_sel_hi:[1,0]
    s_lshl_b32 s1, s50, 10
    v_pk_ashrrev_i16 v16, 15, v16 op_sel_hi:[0,1]
    s_add_u32 s72, s72, s1
    v_pk_ashrrev_i16 v17, 15, v17 op_sel_hi:[0,1]
    s_xor_b32 s73, s72, 4096
    v_pk_ashrrev_i16 v18, 15, v18 op_sel_hi:[0,1]
    s_add_u32 s74, s72, 65536
    v_pk_ashrrev_i16 v19, 15, v19 op_sel_hi:[0,1]
    s_add_u32 s75, s73, 65536
    v_pk_ashrrev_i16 v20, 15, v20 op_sel_hi:[0,1]
    s_lshl_b32 s89, s54, 16
    v_pk_ashrrev_i16 v21, 15, v21 op_sel_hi:[0,1]
    s_lshl_b32 s1, s55, 7
    v_pk_ashrrev_i16 v22, 15, v22 op_sel_hi:[0,1]
    s_add_u32 s89, s89, s1
    v_pk_ashrrev_i16 v23, 15, v23 op_sel_hi:[0,1]
    s_xor_b32 s0, s40, s50
    v_mov_b32 v252, -1
    s_lshl_b32 s0, s0, 14
    v_mov_b32 v253, -1
    s_add_u32 s1, s1, s0
    v_mov_b32 v254, -1
    s_add_u32 s64, s54, 0
    v_mov_b32 v255, -1
    s_and_b32 s64, s64, 3
    s_lshl_b32 s64, s64, 17
    s_add_u32 s64, s64, s1
    s_add_u32 s65, s54, 1
    s_and_b32 s65, s65, 3
    s_lshl_b32 s65, s65, 17
    s_add_u32 s65, s65, s1
    s_add_u32 s66, s54, 2
    s_and_b32 s66, s66, 3
    s_lshl_b32 s66, s66, 17
    s_add_u32 s66, s66, s1
    s_add_u32 s67, s54, 3
    s_and_b32 s67, s67, 3
    s_lshl_b32 s67, s67, 17
    s_add_u32 s67, s67, s1
    s_lshl_b32 s0, s44, 14
    s_add_u32 s69, s0, s63
    s_lshl_b32 s86, s40, 12
    s_add_u32 s86, s86, s0
    s_sub_u32 s68, s86, 65536
    s_and_b32 s68, s68, 0xffffff
    s_sub_u32 s86, s86, 32768
    s_and_b32 s86, s86, 0xffffff
    s_lshl_b32 s0, s40, 7
    s_add_u32 s0, s0, s3
    s_lshl_b32 s1, s70, 3
    s_add_u32 s1, s1, s40
    s_cmp_lt_u32 s1, 4
    s_cselect_b32 s0, s0, s62
    s_cmp_eq_u32 s40, 4
    s_cselect_b32 s0, s49, s0
    s_mov_b32 exec_lo, 0xff
    s_mov_b32 exec_hi, 0x0
    buffer_store_dwordx4 v[252:255], v2, s[16:19], s0 offen sc1
    s_mov_b64 exec, -1
    s_add_u32 s52, s45, 1
    s_and_b32 s52, s52, 7
    s_lshl_b32 s52, s52, 7
    s_add_u32 m0, s63, 34816
    s_nop 0
    buffer_load_dwordx4 v3, s[4:7], s52 offen offset:0 lds
    buffer_load_dwordx4 v125, s[4:7], s52 offen offset:1024 lds
    s_add_u32 m0, s63, 50176
    s_nop 0
    buffer_load_dwordx4 v4, s[92:95], s33 offen offset:1024 lds
    buffer_load_dwordx4 v4, s[92:95], s33 offen offset:2048 lds
    s_waitcnt vmcnt(5) lgkmcnt(0)
    s_barrier
    ds_read_b128 v[112:115], v120 offset:2048
    ds_read_b128 v[116:119], v121
    ds_read_b128 v[96:99], v8 offset:10240
    ds_read_b128 v[100:103], v8 offset:12288
    ds_read_b128 v[104:107], v9 offset:10240
    ds_read_b128 v[108:111], v9 offset:12288
    ds_read_b64_tr_b16 v[64:65], v124 offset:18432
    ds_read_b64_tr_b16 v[66:67], v124 offset:18944
    ds_read_b64_tr_b16 v[68:69], v124 offset:19456
    ds_read_b64_tr_b16 v[70:71], v124 offset:19968
    ds_read_b64_tr_b16 v[72:73], v124 offset:26624
    ds_read_b64_tr_b16 v[74:75], v124 offset:27136
    ds_read_b64_tr_b16 v[76:77], v124 offset:27648
    ds_read_b64_tr_b16 v[78:79], v124 offset:28160
    s_mul_i32 s46, s82, 0x9E3779B1
    s_add_u32 s46, s46, 0x7F4A7C15
    s_cmp_eq_u32 s46, -1
    s_cselect_b32 s46, 0x2545F491, s46
    s_waitcnt lgkmcnt(8)
    ds_read_b128 v[128:131], v8 offset:2048
    ds_read_b128 v[132:135], v8 offset:4096
    ds_read_b128 v[136:139], v9 offset:2048
    ds_read_b128 v[140:143], v9 offset:4096
    ds_read_b64_tr_b16 v[12:13], v122
    ds_read_b64_tr_b16 v[14:15], v122 offset:128
    s_add_u32 m0, s63, 67584
    s_nop 0
    buffer_load_dwordx4 v3, s[4:7], s76 offen offset:0 lds
    buffer_load_dwordx4 v125, s[4:7], s76 offen offset:1024 lds
    s_add_u32 m0, s63, 82944
    s_nop 0
    buffer_load_dwordx4 v4, s[92:95], s34 offen offset:1024 lds
    s_waitcnt vmcnt(3) lgkmcnt(0)
    s_barrier
    v_mfma_f32_16x16x32_bf16 v[80:83], v[116:119], v[112:115], 0
    ds_read_b128 v[144:147], v8 offset:34816
    ds_read_b128 v[148:151], v8 offset:36864
    v_mfma_f32_16x16x32_bf16 v[48:51], v[64:67], v[96:99], 0
    ds_read_b128 v[152:155], v9 offset:34816
    ds_read_b128 v[156:159], v9 offset:36864
    ds_read_b128 v[112:115], v120 offset:34816
    v_mfma_f32_16x16x32_bf16 v[52:55], v[64:67], v[100:103], 0
    buffer_load_dwordx4 v4, s[92:95], s34 offen offset:2048 lds
    s_add_u32 m0, s63, 100352
    v_mfma_f32_16x16x32_bf16 v[56:59], v[68:71], v[96:99], 0
    buffer_load_dwordx4 v3, s[4:7], s77 offen offset:0 lds
    v_xor_b32 v12, v12, v123
    v_xor_b32 v13, v13, v123
    v_mfma_f32_16x16x32_bf16 v[60:63], v[68:71], v[100:103], 0
    v_xor_b32 v14, v14, v123
    v_xor_b32 v15, v15, v123
    v_mfma_f32_16x16x32_bf16 v[48:51], v[72:75], v[104:107], v[48:51]
    buffer_load_dwordx4 v125, s[4:7], s77 offen offset:1024 lds
    s_add_u32 m0, s63, 115712
    v_mov_b32 v121, v80
    v_mfma_f32_16x16x32_bf16 v[52:55], v[72:75], v[108:111], v[52:55]
    ds_read_b64_tr_b16 v[80:81], v124 offset:51200
    ds_read_b64_tr_b16 v[82:83], v124 offset:51712
    v_mfma_f32_16x16x32_bf16 v[56:59], v[76:79], v[104:107], v[56:59]
    ds_read_b64_tr_b16 v[84:85], v124 offset:52224
    ds_read_b64_tr_b16 v[86:87], v124 offset:52736
    ds_read_b64_tr_b16 v[88:89], v124 offset:59392
    v_mfma_f32_16x16x32_bf16 v[60:63], v[76:79], v[108:111], v[60:63]
    ds_read_b64_tr_b16 v[90:91], v124 offset:59904
    ds_read_b64_tr_b16 v[92:93], v124 offset:60416
    ds_read_b64_tr_b16 v[94:95], v124 offset:60928
    v_mfma_f32_16x16x32_bf16 v[32:35], v[64:67], v[128:131], 0
    s_waitcnt lgkmcnt(10)
    ds_read_b128 v[96:99], v8 offset:43008
    v_mfma_f32_16x16x32_bf16 v[36:39], v[64:67], v[132:135], 0
    ds_read_b128 v[100:103], v8 offset:45056
    ds_read_b128 v[104:107], v9 offset:43008
    v_mfma_f32_16x16x32_bf16 v[40:43], v[68:71], v[128:131], 0
    ds_read_b128 v[108:111], v9 offset:45056
    buffer_load_dwordx4 v4, s[92:95], s35 offen offset:1024 lds
    v_mfma_f32_16x16x32_bf16 v[44:47], v[68:71], v[132:135], 0
    buffer_load_dwordx4 v4, s[92:95], s35 offen offset:2048 lds
    s_add_u32 m0, s63, 2048
    v_mfma_f32_16x16x32_bf16 v[32:35], v[72:75], v[136:139], v[32:35]
    v_xor_b32 v8, 0x10000, v8
    v_xor_b32 v9, 0x10000, v9
    v_mfma_f32_16x16x32_bf16 v[36:39], v[72:75], v[140:143], v[36:39]
    v_xor_b32 v120, 0x10000, v120
    buffer_load_dwordx4 v3, s[4:7], s78 offen offset:0 lds
    v_mfma_f32_16x16x32_bf16 v[40:43], v[76:79], v[136:139], v[40:43]
    v_mfma_f32_16x16x32_bf16 v[44:47], v[76:79], v[140:143], v[44:47]
    s_waitcnt vmcnt(5) lgkmcnt(0)
    s_barrier
    v_mfma_f32_16x16x32_bf16 v[64:67], v[116:119], v[112:115], 0
    ds_read_b128 v[160:163], v8 offset:2048
    v_mfma_f32_16x16x32_bf16 v[48:51], v[80:83], v[96:99], v[48:51]
    ds_read_b128 v[164:167], v8 offset:4096
    ds_read_b128 v[168:171], v9 offset:2048
    v_mfma_f32_16x16x32_bf16 v[52:55], v[80:83], v[100:103], v[52:55]
    ds_read_b128 v[172:175], v9 offset:4096
    ds_read_b128 v[112:115], v120 offset:2048
    v_mfma_f32_16x16x32_bf16 v[56:59], v[84:87], v[96:99], v[56:59]
    buffer_load_dwordx4 v125, s[4:7], s78 offen offset:1024 lds
    s_add_u32 m0, s63, 17408
    v_mfma_f32_16x16x32_bf16 v[60:63], v[84:87], v[100:103], v[60:63]
    buffer_load_dwordx4 v4, s[92:95], s36 offen offset:1024 lds
    v_add_f32 v121, v121, v65
    v_mfma_f32_16x16x32_bf16 v[48:51], v[88:91], v[104:107], v[48:51]
    ds_read_b64_tr_b16 v[64:65], v6 offset:0
    ds_read_b64_tr_b16 v[66:67], v6 offset:512
    v_mfma_f32_16x16x32_bf16 v[52:55], v[88:91], v[108:111], v[52:55]
    ds_read_b64_tr_b16 v[68:69], v6 offset:1024
    ds_read_b64_tr_b16 v[70:71], v6 offset:1536
    v_mfma_f32_16x16x32_bf16 v[56:59], v[92:95], v[104:107], v[56:59]
    ds_read_b64_tr_b16 v[72:73], v6 offset:8192
    ds_read_b64_tr_b16 v[74:75], v6 offset:8704
    v_mfma_f32_16x16x32_bf16 v[60:63], v[92:95], v[108:111], v[60:63]
    ds_read_b64_tr_b16 v[76:77], v6 offset:9216
    ds_read_b64_tr_b16 v[78:79], v6 offset:9728
    v_mfma_f32_16x16x32_bf16 v[32:35], v[80:83], v[144:147], v[32:35]
    s_waitcnt lgkmcnt(10)
    v_mfma_f32_16x16x32_bf16 v[36:39], v[80:83], v[148:151], v[36:39]
    ds_read_b128 v[96:99], v8 offset:10240
    v_mfma_f32_16x16x32_bf16 v[40:43], v[84:87], v[144:147], v[40:43]
    ds_read_b128 v[100:103], v8 offset:12288
    ds_read_b128 v[104:107], v9 offset:10240
    v_mfma_f32_16x16x32_bf16 v[44:47], v[84:87], v[148:151], v[44:47]
    ds_read_b128 v[108:111], v9 offset:12288
    v_mfma_f32_16x16x32_bf16 v[32:35], v[88:91], v[152:155], v[32:35]
    buffer_load_dwordx4 v4, s[92:95], s36 offen offset:2048 lds
    v_mfma_f32_16x16x32_bf16 v[36:39], v[88:91], v[156:159], v[36:39]
    s_add_u32 m0, s63, 34816
    s_nop 0
    buffer_load_dwordx4 v3, s[4:7], s79 offen offset:0 lds
    v_mfma_f32_16x16x32_bf16 v[40:43], v[92:95], v[152:155], v[40:43]
    v_mfma_f32_16x16x32_bf16 v[44:47], v[92:95], v[156:159], v[44:47]
    s_waitcnt vmcnt(5) lgkmcnt(0)
    s_barrier
    v_mfma_f32_16x16x32_bf16 v[80:83], v[116:119], v[112:115], 0
    ds_read_b128 v[176:179], v8 offset:34816
    v_mfma_f32_16x16x32_bf16 v[48:51], v[64:67], v[96:99], v[48:51]
    ds_read_b128 v[180:183], v8 offset:36864
    ds_read_b128 v[184:187], v9 offset:34816
    v_mfma_f32_16x16x32_bf16 v[52:55], v[64:67], v[100:103], v[52:55]
    ds_read_b128 v[188:191], v9 offset:36864
    ds_read_b128 v[112:115], v120 offset:34816
    v_mfma_f32_16x16x32_bf16 v[56:59], v[68:71], v[96:99], v[56:59]
    buffer_load_dwordx4 v125, s[4:7], s79 offen offset:1024 lds
    s_add_u32 m0, s63, 50176
    v_mfma_f32_16x16x32_bf16 v[60:63], v[68:71], v[100:103], v[60:63]
    buffer_load_dwordx4 v4, s[92:95], s37 offen offset:1024 lds
    v_add_f32 v121, v121, v82
    v_mfma_f32_16x16x32_bf16 v[48:51], v[72:75], v[104:107], v[48:51]
    ds_read_b64_tr_b16 v[80:81], v6 offset:32768
    ds_read_b64_tr_b16 v[82:83], v6 offset:33280
    v_mfma_f32_16x16x32_bf16 v[52:55], v[72:75], v[108:111], v[52:55]
    ds_read_b64_tr_b16 v[84:85], v6 offset:33792
    ds_read_b64_tr_b16 v[86:87], v6 offset:34304
    v_mfma_f32_16x16x32_bf16 v[56:59], v[76:79], v[104:107], v[56:59]
    ds_read_b64_tr_b16 v[88:89], v6 offset:40960
    ds_read_b64_tr_b16 v[90:91], v6 offset:41472
    v_mfma_f32_16x16x32_bf16 v[60:63], v[76:79], v[108:111], v[60:63]
    ds_read_b64_tr_b16 v[92:93], v6 offset:41984
    ds_read_b64_tr_b16 v[94:95], v6 offset:42496
    v_mfma_f32_16x16x32_bf16 v[32:35], v[64:67], v[160:163], v[32:35]
    s_waitcnt lgkmcnt(10)
    v_mfma_f32_16x16x32_bf16 v[36:39], v[64:67], v[164:167], v[36:39]
    ds_read_b128 v[96:99], v8 offset:43008
    ds_read_b128 v[100:103], v8 offset:45056
    v_mfma_f32_16x16x32_bf16 v[40:43], v[68:71], v[160:163], v[40:43]
    ds_read_b128 v[104:107], v9 offset:43008
    ds_read_b128 v[108:111], v9 offset:45056
    v_mfma_f32_16x16x32_bf16 v[44:47], v[68:71], v[164:167], v[44:47]
    buffer_load_dwordx4 v4, s[92:95], s37 offen offset:2048 lds
    s_add_u32 m0, s63, 67584
    v_mfma_f32_16x16x32_bf16 v[32:35], v[72:75], v[168:171], v[32:35]
    v_xor_b32 v8, 0x10000, v8
    v_xor_b32 v9, 0x10000, v9
    v_mfma_f32_16x16x32_bf16 v[36:39], v[72:75], v[172:175], v[36:39]
    v_xor_b32 v120, 0x10000, v120
    buffer_load_dwordx4 v3, s[4:7], s80 offen offset:0 lds
    v_mfma_f32_16x16x32_bf16 v[40:43], v[76:79], v[168:171], v[40:43]
    v_mfma_f32_16x16x32_bf16 v[44:47], v[76:79], v[172:175], v[44:47]
    s_waitcnt vmcnt(5) lgkmcnt(0)
    s_barrier
    v_mfma_f32_16x16x32_bf16 v[64:67], v[116:119], v[112:115], 0
    ds_read_b128 v[192:195], v8 offset:2048
    v_mfma_f32_16x16x32_bf16 v[48:51], v[80:83], v[96:99], v[48:51]
    ds_read_b128 v[196:199], v8 offset:4096
    ds_read_b128 v[200:203], v9 offset:2048
    v_mfma_f32_16x16x32_bf16 v[52:55], v[80:83], v[100:103], v[52:55]
    ds_read_b128 v[204:207], v9 offset:4096
    ds_read_b128 v[112:115], v120 offset:2048
    v_mfma_f32_16x16x32_bf16 v[56:59], v[84:87], v[96:99], v[56:59]
    buffer_load_dwordx4 v125, s[4:7], s80 offen offset:1024 lds
    s_add_u32 m0, s63, 82944
    v_mfma_f32_16x16x32_bf16 v[60:63], v[84:87], v[100:103], v[60:63]
    buffer_load_dwordx4 v4, s[92:95], s38 offen offset:1024 lds
    v_add_f32 v121, v121, v67
    v_mfma_f32_16x16x32_bf16 v[48:51], v[88:91], v[104:107], v[48:51]
    ds_read_b64_tr_b16 v[64:65], v124 offset:18432
    ds_read_b64_tr_b16 v[66:67], v124 offset:18944
    v_mfma_f32_16x16x32_bf16 v[52:55], v[88:91], v[108:111], v[52:55]
    ds_read_b64_tr_b16 v[68:69], v124 offset:19456
    ds_read_b64_tr_b16 v[70:71], v124 offset:19968
    v_mfma_f32_16x16x32_bf16 v[56:59], v[92:95], v[104:107], v[56:59]
    ds_read_b64_tr_b16 v[72:73], v124 offset:26624
    ds_read_b64_tr_b16 v[74:75], v124 offset:27136
    v_mfma_f32_16x16x32_bf16 v[60:63], v[92:95], v[108:111], v[60:63]
    ds_read_b64_tr_b16 v[76:77], v124 offset:27648
    ds_read_b64_tr_b16 v[78:79], v124 offset:28160
    v_mfma_f32_16x16x32_bf16 v[32:35], v[80:83], v[176:179], v[32:35]
    s_waitcnt lgkmcnt(10)
    v_mfma_f32_16x16x32_bf16 v[36:39], v[80:83], v[180:183], v[36:39]
    ds_read_b128 v[96:99], v8 offset:10240
    v_mfma_f32_16x16x32_bf16 v[40:43], v[84:87], v[176:179], v[40:43]
    ds_read_b128 v[100:103], v8 offset:12288
    ds_read_b128 v[104:107], v9 offset:10240
    v_mfma_f32_16x16x32_bf16 v[44:47], v[84:87], v[180:183], v[44:47]
    ds_read_b128 v[108:111], v9 offset:12288
    v_mfma_f32_16x16x32_bf16 v[32:35], v[88:91], v[184:187], v[32:35]
    buffer_load_dwordx4 v4, s[92:95], s38 offen offset:2048 lds
    v_mfma_f32_16x16x32_bf16 v[36:39], v[88:91], v[188:191], v[36:39]
    s_add_u32 m0, s63, 100352
    s_nop 0
    buffer_load_dwordx4 v3, s[4:7], s81 offen offset:0 lds
    v_mfma_f32_16x16x32_bf16 v[40:43], v[92:95], v[184:187], v[40:43]
    v_mfma_f32_16x16x32_bf16 v[44:47], v[92:95], v[188:191], v[44:47]
    s_waitcnt vmcnt(5) lgkmcnt(0)
    s_barrier
    v_mfma_f32_16x16x32_bf16 v[80:83], v[116:119], v[112:115], 0
    ds_read_b128 v[208:211], v8 offset:34816
    v_mfma_f32_16x16x32_bf16 v[48:51], v[64:67], v[96:99], v[48:51]
    ds_read_b128 v[212:215], v8 offset:36864
    ds_read_b128 v[216:219], v9 offset:34816
    v_mfma_f32_16x16x32_bf16 v[52:55], v[64:67], v[100:103], v[52:55]
    ds_read_b128 v[220:223], v9 offset:36864
    ds_read_b128 v[112:115], v120 offset:34816
    v_mfma_f32_16x16x32_bf16 v[56:59], v[68:71], v[96:99], v[56:59]
    buffer_load_dwordx4 v125, s[4:7], s81 offen offset:1024 lds
    s_add_u32 m0, s63, 115712
    v_mfma_f32_16x16x32_bf16 v[60:63], v[68:71], v[100:103], v[60:63]
    buffer_load_dwordx4 v4, s[92:95], s39 offen offset:1024 lds
    v_mov_b32 v122, v80
    v_mfma_f32_16x16x32_bf16 v[48:51], v[72:75], v[104:107], v[48:51]
    ds_read_b64_tr_b16 v[80:81], v124 offset:51200
    ds_read_b64_tr_b16 v[82:83], v124 offset:51712
    v_mfma_f32_16x16x32_bf16 v[52:55], v[72:75], v[108:111], v[52:55]
    ds_read_b64_tr_b16 v[84:85], v124 offset:52224
    ds_read_b64_tr_b16 v[86:87], v124 offset:52736
    v_mfma_f32_16x16x32_bf16 v[56:59], v[76:79], v[104:107], v[56:59]
    ds_read_b64_tr_b16 v[88:89], v124 offset:59392
    ds_read_b64_tr_b16 v[90:91], v124 offset:59904
    v_mfma_f32_16x16x32_bf16 v[60:63], v[76:79], v[108:111], v[60:63]
    ds_read_b64_tr_b16 v[92:93], v124 offset:60416
    ds_read_b64_tr_b16 v[94:95], v124 offset:60928
    v_mfma_f32_16x16x32_bf16 v[32:35], v[64:67], v[192:195], v[32:35]
    s_waitcnt lgkmcnt(10)
    ds_read_b128 v[96:99], v8 offset:43008
    v_mfma_f32_16x16x32_bf16 v[36:39], v[64:67], v[196:199], v[36:39]
    ds_read_b128 v[100:103], v8 offset:45056
    ds_read_b128 v[104:107], v9 offset:43008
    v_mfma_f32_16x16x32_bf16 v[40:43], v[68:71], v[192:195], v[40:43]
    ds_read_b128 v[108:111], v9 offset:45056
    buffer_load_dwordx4 v4, s[92:95], s39 offen offset:2048 lds
    v_mfma_f32_16x16x32_bf16 v[44:47], v[68:71], v[196:199], v[44:47]
    s_add_u32 m0, s63, 2048
    v_xor_b32 v8, 0x10000, v8
    v_mfma_f32_16x16x32_bf16 v[32:35], v[72:75], v[200:203], v[32:35]
    v_xor_b32 v9, 0x10000, v9
    v_xor_b32 v120, 0x10000, v120
    v_mfma_f32_16x16x32_bf16 v[36:39], v[72:75], v[204:207], v[36:39]
    s_cmp_ge_u32 s40, 4
    s_cbranch_scc1 Lpf_5
    s_and_b32 s50, s44, 15
    s_lshl_b32 s50, s50, 1
    s_add_u32 s50, s50, s41
    s_mul_i32 s50, s50, 49152
    s_lshl_b32 s51, s43, 7
    s_add_u32 s50, s50, s51
    v_mul_u32_u24 v126, 3072, v1
    s_mov_b32 exec_lo, 0xffff
    s_mov_b32 exec_hi, 0x0
    s_cmp_ge_u32 s40, 2
    s_cbranch_scc1 Lpf_6
    buffer_load_dword v127, v126, s[8:11], s50 offen
    s_branch Lpf_8
Lpf_6:
    buffer_load_dword v127, v126, s[12:15], s50 offen offset:1024
    s_branch Lpf_8
Lpf_5:
    s_lshl_b32 s50, s2, 11
    s_and_b32 s51, s47, 1024
    s_add_u32 s50, s50, s51
    s_mov_b32 exec_lo, 0xff
    s_mov_b32 exec_hi, 0x0
    s_cmp_ge_u32 s40, 6
    s_cbranch_scc1 Lpf_7
    buffer_load_dword v127, v24, s[20:23], s50 offen
    s_branch Lpf_8
Lpf_7:
    buffer_load_dword v127, v24, s[24:27], s50 offen
Lpf_8:
    s_mov_b64 exec, -1
    buffer_load_dwordx4 v4, s[8:11], s32 offen offset:0 lds
    v_mfma_f32_16x16x32_bf16 v[40:43], v[76:79], v[200:203], v[40:43]
    v_mfma_f32_16x16x32_bf16 v[44:47], v[76:79], v[204:207], v[44:47]
    s_waitcnt vmcnt(6) lgkmcnt(0)
    s_barrier
    v_mfma_f32_16x16x32_bf16 v[64:67], v[116:119], v[112:115], 0
    ds_read_b128 v[224:227], v8 offset:2048
    v_mfma_f32_16x16x32_bf16 v[48:51], v[80:83], v[96:99], v[48:51]
    ds_read_b128 v[228:231], v8 offset:4096
    ds_read_b128 v[232:235], v9 offset:2048
    v_mfma_f32_16x16x32_bf16 v[52:55], v[80:83], v[100:103], v[52:55]
    ds_read_b128 v[236:239], v9 offset:4096
    ds_read_b128 v[112:115], v120 offset:2048
    v_mfma_f32_16x16x32_bf16 v[56:59], v[84:87], v[96:99], v[56:59]
    buffer_load_dwordx4 v4, s[12:15], s32 offen offset:1024 lds
    s_add_u32 m0, s63, 18432
    v_mfma_f32_16x16x32_bf16 v[60:63], v[84:87], v[100:103], v[60:63]
    buffer_load_dwordx4 v4, s[8:11], s33 offen offset:0 lds
    v_add_f32 v122, v122, v65
    v_mfma_f32_16x16x32_bf16 v[48:51], v[88:91], v[104:107], v[48:51]
    ds_read_b64_tr_b16 v[64:65], v6 offset:0
    ds_read_b64_tr_b16 v[66:67], v6 offset:512
    v_mfma_f32_16x16x32_bf16 v[52:55], v[88:91], v[108:111], v[52:55]
    ds_read_b64_tr_b16 v[68:69], v6 offset:1024
    ds_read_b64_tr_b16 v[70:71], v6 offset:1536
    v_mfma_f32_16x16x32_bf16 v[56:59], v[92:95], v[104:107], v[56:59]
    ds_read_b64_tr_b16 v[72:73], v6 offset:8192
    ds_read_b64_tr_b16 v[74:75], v6 offset:8704
    v_mfma_f32_16x16x32_bf16 v[60:63], v[92:95], v[108:111], v[60:63]
    ds_read_b64_tr_b16 v[76:77], v6 offset:9216
    ds_read_b64_tr_b16 v[78:79], v6 offset:9728
    v_mfma_f32_16x16x32_bf16 v[32:35], v[80:83], v[208:211], v[32:35]
    s_waitcnt lgkmcnt(10)
    v_mfma_f32_16x16x32_bf16 v[36:39], v[80:83], v[212:215], v[36:39]
    ds_read_b128 v[96:99], v8 offset:10240
    v_mfma_f32_16x16x32_bf16 v[40:43], v[84:87], v[208:211], v[40:43]
    ds_read_b128 v[100:103], v8 offset:12288
    v_mfma_f32_16x16x32_bf16 v[44:47], v[84:87], v[212:215], v[44:47]
    ds_read_b128 v[104:107], v9 offset:10240
    v_mfma_f32_16x16x32_bf16 v[32:35], v[88:91], v[216:219], v[32:35]
    ds_read_b128 v[108:111], v9 offset:12288
    v_mfma_f32_16x16x32_bf16 v[36:39], v[88:91], v[220:223], v[36:39]
    buffer_load_dwordx4 v4, s[12:15], s33 offen offset:1024 lds
    v_mfma_f32_16x16x32_bf16 v[40:43], v[92:95], v[216:219], v[40:43]
    v_mfma_f32_16x16x32_bf16 v[44:47], v[92:95], v[220:223], v[44:47]
    s_waitcnt vmcnt(5) lgkmcnt(0)
    s_barrier
    v_mfma_f32_16x16x32_bf16 v[80:83], v[116:119], v[112:115], 0
    s_add_u32 m0, s63, 83968
    ds_read_b128 v[240:243], v8 offset:34816
    v_mfma_f32_16x16x32_bf16 v[48:51], v[64:67], v[96:99], v[48:51]
    ds_read_b128 v[244:247], v8 offset:36864
    ds_read_b128 v[248:251], v9 offset:34816
    ds_read_b128 v[252:255], v9 offset:36864
    v_mfma_f32_16x16x32_bf16 v[52:55], v[64:67], v[100:103], v[52:55]
    ds_read_b128 v[112:115], v120 offset:34816
    buffer_load_dwordx4 v4, s[8:11], s34 offen offset:0 lds
    s_lshl_b32 s50, s43, 19
    v_mfma_f32_16x16x32_bf16 v[56:59], v[68:71], v[96:99], v[56:59]
    s_add_u32 s50, s50, 5242880
    s_add_u32 s4, s16, s50
    v_mfma_f32_16x16x32_bf16 v[60:63], v[68:71], v[100:103], v[60:63]
    s_addc_u32 s5, s17, 0
    s_mov_b32 s6, 524288
    s_mov_b32 s7, 0x20000
    v_mfma_f32_16x16x32_bf16 v[48:51], v[72:75], v[104:107], v[48:51]
    s_lshl_b32 s1, s40, 12
    s_add_u32 s1, s1, 2048
    v_add_f32 v122, v122, v82
    v_mfma_f32_16x16x32_bf16 v[52:55], v[72:75], v[108:111], v[52:55]
    ds_read_b64_tr_b16 v[80:81], v6 offset:32768
    ds_read_b64_tr_b16 v[82:83], v6 offset:33280
    v_mfma_f32_16x16x32_bf16 v[56:59], v[76:79], v[104:107], v[56:59]
    ds_read_b64_tr_b16 v[84:85], v6 offset:33792
    ds_read_b64_tr_b16 v[86:87], v6 offset:34304
    ds_read_b64_tr_b16 v[88:89], v6 offset:40960
    v_mfma_f32_16x16x32_bf16 v[60:63], v[76:79], v[108:111], v[60:63]
    ds_read_b64_tr_b16 v[90:91], v6 offset:41472
    ds_read_b64_tr_b16 v[92:93], v6 offset:41984
    ds_read_b64_tr_b16 v[94:95], v6 offset:42496
    v_mfma_f32_16x16x32_bf16 v[32:35], v[64:67], v[224:227], v[32:35]
    s_waitcnt lgkmcnt(10)
    v_mfma_f32_16x16x32_bf16 v[36:39], v[64:67], v[228:231], v[36:39]
    ds_read_b128 v[96:99], v8 offset:43008
    v_mfma_f32_16x16x32_bf16 v[40:43], v[68:71], v[224:227], v[40:43]
    ds_read_b128 v[100:103], v8 offset:45056
    v_mfma_f32_16x16x32_bf16 v[44:47], v[68:71], v[228:231], v[44:47]
    ds_read_b128 v[104:107], v9 offset:43008
    v_mfma_f32_16x16x32_bf16 v[32:35], v[72:75], v[232:235], v[32:35]
    ds_read_b128 v[108:111], v9 offset:45056
    v_mfma_f32_16x16x32_bf16 v[36:39], v[72:75], v[236:239], v[36:39]
    buffer_load_dwordx4 v4, s[12:15], s34 offen offset:1024 lds
    v_mfma_f32_16x16x32_bf16 v[40:43], v[76:79], v[232:235], v[40:43]
    v_mfma_f32_16x16x32_bf16 v[44:47], v[76:79], v[236:239], v[44:47]
    s_waitcnt vmcnt(4) lgkmcnt(0)
    s_barrier
    v_mfma_f32_16x16x32_bf16 v[64:67], v[116:119], v[112:115], 0
    s_add_u32 m0, s63, 100352
    v_mfma_f32_16x16x32_bf16 v[48:51], v[80:83], v[96:99], v[48:51]
    buffer_load_dwordx4 v4, s[8:11], s35 offen offset:0 lds
    v_mfma_f32_16x16x32_bf16 v[52:55], v[80:83], v[100:103], v[52:55]
    v_mov_b32 v8, -1
    v_mfma_f32_16x16x32_bf16 v[56:59], v[84:87], v[96:99], v[56:59]
    v_mov_b32 v9, -1
    v_mov_b32 v10, -1
    v_mfma_f32_16x16x32_bf16 v[60:63], v[84:87], v[100:103], v[60:63]
    v_mov_b32 v11, -1
    v_mfma_f32_16x16x32_bf16 v[48:51], v[88:91], v[104:107], v[48:51]
    buffer_load_dwordx4 v4, s[12:15], s35 offen offset:1024 lds
    v_mfma_f32_16x16x32_bf16 v[52:55], v[88:91], v[108:111], v[52:55]
    s_add_u32 m0, s63, 116736
    v_mfma_f32_16x16x32_bf16 v[56:59], v[92:95], v[104:107], v[56:59]
    v_add_f32 v122, v122, v67
    ds_read_b64_tr_b16 v[64:65], v124 offset:2048
    v_mfma_f32_16x16x32_bf16 v[60:63], v[92:95], v[108:111], v[60:63]
    ds_read_b64_tr_b16 v[66:67], v124 offset:2560
    v_mfma_f32_16x16x32_bf16 v[32:35], v[80:83], v[240:243], v[32:35]
    ds_read_b64_tr_b16 v[68:69], v124 offset:3072
    v_mfma_f32_16x16x32_bf16 v[36:39], v[80:83], v[244:247], v[36:39]
    ds_read_b64_tr_b16 v[70:71], v124 offset:3584
    v_mfma_f32_16x16x32_bf16 v[40:43], v[84:87], v[240:243], v[40:43]
    ds_read_b64_tr_b16 v[72:73], v124 offset:10240
    ds_read_b64_tr_b16 v[74:75], v124 offset:10752
    v_mfma_f32_16x16x32_bf16 v[44:47], v[84:87], v[244:247], v[44:47]
    ds_read_b64_tr_b16 v[76:77], v124 offset:11264
    v_mfma_f32_16x16x32_bf16 v[32:35], v[88:91], v[248:251], v[32:35]
    ds_read_b64_tr_b16 v[78:79], v124 offset:11776
    v_mfma_f32_16x16x32_bf16 v[36:39], v[88:91], v[252:255], v[36:39]
    buffer_load_dwordx4 v4, s[8:11], s36 offen offset:0 lds
    buffer_load_dwordx4 v4, s[12:15], s36 offen offset:1024 lds
    v_mfma_f32_16x16x32_bf16 v[40:43], v[92:95], v[248:251], v[40:43]
    v_mfma_f32_16x16x32_bf16 v[44:47], v[92:95], v[252:255], v[44:47]
    s_cmp_eq_u32 s70, 0
    s_cbranch_scc1 L_roleB
    v_cndmask_b32 v121, v121, v122, s[58:59]
    ds_write_b32 v31, v121
    v_cvt_pk_bf16_f32 v96, v48, v49
    v_cvt_pk_bf16_f32 v97, v50, v51
    v_cvt_pk_bf16_f32 v98, v52, v53
    v_cvt_pk_bf16_f32 v99, v54, v55
    v_cvt_pk_bf16_f32 v100, v56, v57
    v_cvt_pk_bf16_f32 v101, v58, v59
    v_cvt_pk_bf16_f32 v102, v60, v61
    v_cvt_pk_bf16_f32 v103, v62, v63
    v_permlane16_swap_b32 v96, v98
    v_permlane16_swap_b32 v97, v99
    v_permlane16_swap_b32 v100, v102
    v_permlane16_swap_b32 v101, v103
    v_mfma_f32_32x32x16_bf16 v[48:63], v[12:15], v[96:99], 0
    v_cvt_pk_bf16_f32 v112, v32, v33
    v_cvt_pk_bf16_f32 v113, v34, v35
    v_cvt_pk_bf16_f32 v114, v36, v37
    v_cvt_pk_bf16_f32 v115, v38, v39
    v_cvt_pk_bf16_f32 v116, v40, v41
    v_cvt_pk_bf16_f32 v117, v42, v43
    v_cvt_pk_bf16_f32 v118, v44, v45
    v_cvt_pk_bf16_f32 v119, v46, v47
    v_permlane16_swap_b32 v112, v114
    v_permlane16_swap_b32 v113, v115
    v_permlane16_swap_b32 v116, v118
    v_permlane16_swap_b32 v117, v119
    v_mfma_f32_32x32x16_bf16 v[32:47], v[12:15], v[112:115], 0
    v_subrev_u32 v111, 101376, v25
    v_subrev_u32 v110, 32768, v29
    ds_write_b128 v111, v[100:103]
    ds_write_b128 v25, v[116:119]
    v_max3_f32 v81, v48, v49, v50
    v_max3_f32 v82, v51, v52, v53
    v_max3_f32 v83, v54, v55, v56
    v_max3_f32 v84, v57, v58, v59
    v_max3_f32 v85, v60, v61, v62
    v_mov_b32 v80, 0x3fb8aa3b
    v_max3_f32 v81, v81, v82, v63
    v_max3_f32 v83, v83, v84, v85
    v_max3_f32 v105, v32, v33, v34
    v_max_f32 v81, v81, v83
    v_max3_f32 v106, v35, v36, v37
    v_mul_f32 v82, v80, v81
    v_max3_f32 v107, v38, v39, v40
    v_pk_fma_f32 v[48:49], v[48:49], v[80:81], v[82:83] op_sel_hi:[1,0,0] neg_lo:[0,0,1] neg_hi:[0,0,1]
    v_max3_f32 v108, v41, v42, v43
    v_pk_fma_f32 v[50:51], v[50:51], v[80:81], v[82:83] op_sel_hi:[1,0,0] neg_lo:[0,0,1] neg_hi:[0,0,1]
    v_max3_f32 v109, v44, v45, v46
    v_pk_fma_f32 v[52:53], v[52:53], v[80:81], v[82:83] op_sel_hi:[1,0,0] neg_lo:[0,0,1] neg_hi:[0,0,1]
    v_mov_b32 v104, 0x3fb8aa3b
    v_pk_fma_f32 v[54:55], v[54:55], v[80:81], v[82:83] op_sel_hi:[1,0,0] neg_lo:[0,0,1] neg_hi:[0,0,1]
    v_max3_f32 v105, v105, v106, v47
    v_pk_fma_f32 v[56:57], v[56:57], v[80:81], v[82:83] op_sel_hi:[1,0,0] neg_lo:[0,0,1] neg_hi:[0,0,1]
    v_max3_f32 v107, v107, v108, v109
    v_pk_fma_f32 v[58:59], v[58:59], v[80:81], v[82:83] op_sel_hi:[1,0,0] neg_lo:[0,0,1] neg_hi:[0,0,1]
    v_max_f32 v105, v105, v107
    buffer_store_dwordx4 v[8:11], v30, s[16:19], s60 offen offset:0 sc1
    v_pk_fma_f32 v[60:61], v[60:61], v[80:81], v[82:83] op_sel_hi:[1,0,0] neg_lo:[0,0,1] neg_hi:[0,0,1]
    v_mul_f32 v106, v104, v105
    v_pk_fma_f32 v[62:63], v[62:63], v[80:81], v[82:83] op_sel_hi:[1,0,0] neg_lo:[0,0,1] neg_hi:[0,0,1]
    v_pk_fma_f32 v[32:33], v[32:33], v[104:105], v[106:107] op_sel_hi:[1,0,0] neg_lo:[0,0,1] neg_hi:[0,0,1]
    v_exp_f32 v48, v48
    v_pk_fma_f32 v[34:35], v[34:35], v[104:105], v[106:107] op_sel_hi:[1,0,0] neg_lo:[0,0,1] neg_hi:[0,0,1]
    v_exp_f32 v49, v49
    v_pk_fma_f32 v[36:37], v[36:37], v[104:105], v[106:107] op_sel_hi:[1,0,0] neg_lo:[0,0,1] neg_hi:[0,0,1]
    v_exp_f32 v50, v50
    v_pk_fma_f32 v[38:39], v[38:39], v[104:105], v[106:107] op_sel_hi:[1,0,0] neg_lo:[0,0,1] neg_hi:[0,0,1]
    v_exp_f32 v51, v51
    v_pk_fma_f32 v[40:41], v[40:41], v[104:105], v[106:107] op_sel_hi:[1,0,0] neg_lo:[0,0,1] neg_hi:[0,0,1]
    v_exp_f32 v52, v52
    v_pk_fma_f32 v[42:43], v[42:43], v[104:105], v[106:107] op_sel_hi:[1,0,0] neg_lo:[0,0,1] neg_hi:[0,0,1]
    v_pk_add_f32 v[80:81], v[48:49], v[50:51]
    v_pk_fma_f32 v[44:45], v[44:45], v[104:105], v[106:107] op_sel_hi:[1,0,0] neg_lo:[0,0,1] neg_hi:[0,0,1]
    v_exp_f32 v53, v53
    v_pk_fma_f32 v[46:47], v[46:47], v[104:105], v[106:107] op_sel_hi:[1,0,0] neg_lo:[0,0,1] neg_hi:[0,0,1]
    v_exp_f32 v54, v54
    v_exp_f32 v32, v32
    v_pk_add_f32 v[80:81], v[80:81], v[52:53]
    v_exp_f32 v33, v33
    v_exp_f32 v55, v55
    v_exp_f32 v34, v34
    v_exp_f32 v56, v56
    s_mov_b32 exec_lo, 0xf000f
    s_mov_b32 exec_hi, 0xf000f
    buffer_store_dwordx4 v[8:11], v30, s[16:19], s60 offen offset:256 sc1
    s_mov_b64 exec, -1
    v_exp_f32 v35, v35
    v_pk_add_f32 v[80:81], v[80:81], v[54:55]
    v_exp_f32 v36, v36
    v_exp_f32 v57, v57
    v_pk_add_f32 v[104:105], v[32:33], v[34:35]
    v_exp_f32 v58, v58
    v_exp_f32 v37, v37
    v_pk_add_f32 v[80:81], v[80:81], v[56:57]
    v_exp_f32 v38, v38
    v_exp_f32 v59, v59
    v_pk_add_f32 v[104:105], v[104:105], v[36:37]
    v_exp_f32 v60, v60
    v_exp_f32 v39, v39
    v_pk_add_f32 v[80:81], v[80:81], v[58:59]
    v_exp_f32 v40, v40
    v_exp_f32 v61, v61
    v_pk_add_f32 v[104:105], v[104:105], v[38:39]
    v_exp_f32 v62, v62
    v_exp_f32 v41, v41
    v_pk_add_f32 v[80:81], v[80:81], v[60:61]
    v_exp_f32 v42, v42
    v_exp_f32 v63, v63
    v_pk_add_f32 v[104:105], v[104:105], v[40:41]
    v_pk_add_f32 v[80:81], v[80:81], v[62:63]
    v_exp_f32 v43, v43
    buffer_store_dwordx4 v[8:11], v2, s[16:19], s56 offen sc1
    v_add_f32 v80, v80, v81
    v_exp_f32 v44, v44
    v_rcp_f32 v80, v80
    v_pk_add_f32 v[104:105], v[104:105], v[42:43]
    v_pk_mul_f32 v[48:49], v[48:49], v[80:81] op_sel_hi:[1,0]
    v_exp_f32 v45, v45
    v_pk_mul_f32 v[50:51], v[50:51], v[80:81] op_sel_hi:[1,0]
    v_exp_f32 v46, v46
    v_pk_mul_f32 v[52:53], v[52:53], v[80:81] op_sel_hi:[1,0]
    v_pk_add_f32 v[104:105], v[104:105], v[44:45]
    v_pk_mul_f32 v[54:55], v[54:55], v[80:81] op_sel_hi:[1,0]
    v_exp_f32 v47, v47
    v_pk_mul_f32 v[56:57], v[56:57], v[80:81] op_sel_hi:[1,0]
    v_pk_add_f32 v[104:105], v[104:105], v[46:47]
    v_pk_mul_f32 v[58:59], v[58:59], v[80:81] op_sel_hi:[1,0]
    v_add_f32 v104, v104, v105
    v_pk_mul_f32 v[60:61], v[60:61], v[80:81] op_sel_hi:[1,0]
    v_rcp_f32 v104, v104
    v_pk_mul_f32 v[62:63], v[62:63], v[80:81] op_sel_hi:[1,0]
    v_pk_mul_f32 v[32:33], v[32:33], v[104:105] op_sel_hi:[1,0]
    v_cvt_pk_bf16_f32 v48, v48, v49
    v_pk_mul_f32 v[34:35], v[34:35], v[104:105] op_sel_hi:[1,0]
    v_cvt_pk_bf16_f32 v49, v50, v51
    v_pk_mul_f32 v[36:37], v[36:37], v[104:105] op_sel_hi:[1,0]
    v_cvt_pk_bf16_f32 v50, v52, v53
    buffer_store_dwordx4 v[8:11], v2, s[16:19], s57 offen sc1
    v_pk_mul_f32 v[38:39], v[38:39], v[104:105] op_sel_hi:[1,0]
    v_cvt_pk_bf16_f32 v51, v54, v55
    v_pk_mul_f32 v[40:41], v[40:41], v[104:105] op_sel_hi:[1,0]
    ds_write_b128 v110, v[48:51] offset:0
    v_pk_mul_f32 v[42:43], v[42:43], v[104:105] op_sel_hi:[1,0]
    v_cvt_pk_bf16_f32 v52, v56, v57
    v_pk_mul_f32 v[44:45], v[44:45], v[104:105] op_sel_hi:[1,0]
    v_cvt_pk_bf16_f32 v53, v58, v59
    v_pk_mul_f32 v[46:47], v[46:47], v[104:105] op_sel_hi:[1,0]
    v_cvt_pk_bf16_f32 v54, v60, v61
    v_cvt_pk_bf16_f32 v32, v32, v33
    v_cvt_pk_bf16_f32 v55, v62, v63
    v_cvt_pk_bf16_f32 v33, v34, v35
    ds_write_b128 v110, v[52:55] offset:1024
    v_cvt_pk_bf16_f32 v34, v36, v37
    v_cvt_pk_bf16_f32 v35, v38, v39
    ds_write_b128 v110, v[32:35] offset:32768
    v_cvt_pk_bf16_f32 v36, v40, v41
    v_cvt_pk_bf16_f32 v37, v42, v43
    v_cvt_pk_bf16_f32 v38, v44, v45
    v_cvt_pk_bf16_f32 v39, v46, v47
    ds_write_b128 v110, v[36:39] offset:33792
    v_mov_b32 v120, 0x3f803f80
    v_mov_b32 v121, 0x3f803f80
    v_mov_b32 v122, 0x3f803f80
    v_mov_b32 v123, 0x3f803f80
    v_subrev_u32 v26, 32768, v26
    v_subrev_u32 v25, 101376, v27
    s_waitcnt vmcnt(10) lgkmcnt(0)
    s_barrier
    v_mfma_f32_16x16x32_bf16 v[96:99], v[64:67], v[128:131], 0
    s_add_u32 m0, s63, 2048
    ds_read_b64_tr_b16 v[80:81], v124 offset:18432
    ds_read_b64_tr_b16 v[82:83], v124 offset:18944
    ds_read_b64_tr_b16 v[84:85], v124 offset:19456
    ds_read_b64_tr_b16 v[86:87], v124 offset:19968
    v_mfma_f32_16x16x32_bf16 v[100:103], v[64:67], v[132:135], 0
    buffer_load_dwordx4 v4, s[8:11], s37 offen offset:0 lds
    ds_read_b64_tr_b16 v[32:33], v26 offset:0
    ds_read_b64_tr_b16 v[36:37], v25 offset:0
    ds_read_b64_tr_b16 v[34:35], v26 offset:64
    ds_read_b64_tr_b16 v[38:39], v25 offset:64
    ds_read_b64_tr_b16 v[40:41], v26 offset:8192
    v_mfma_f32_16x16x32_bf16 v[104:107], v[68:71], v[128:131], 0
    ds_read_b64_tr_b16 v[44:45], v25 offset:1152
    ds_read_b64_tr_b16 v[42:43], v26 offset:8256
    ds_read_b64_tr_b16 v[46:47], v25 offset:1216
    s_waitcnt lgkmcnt(10)
    ds_read_b64_tr_b16 v[88:89], v124 offset:26624
    v_mfma_f32_16x16x32_bf16 v[108:111], v[68:71], v[132:135], 0
    ds_read_b64_tr_b16 v[90:91], v124 offset:27136
    ds_read_b64_tr_b16 v[92:93], v124 offset:27648
    ds_read_b64_tr_b16 v[94:95], v124 offset:28160
    s_waitcnt lgkmcnt(4)
    ds_read_b64_tr_b16 v[48:49], v26 offset:32768
    ds_read_b64_tr_b16 v[52:53], v27 offset:0
    v_mfma_f32_16x16x32_bf16 v[96:99], v[72:75], v[136:139], v[96:99]
    ds_read_b64_tr_b16 v[50:51], v26 offset:32832
    ds_read_b64_tr_b16 v[54:55], v27 offset:64
    ds_read_b64_tr_b16 v[56:57], v26 offset:40960
    ds_read_b64_tr_b16 v[60:61], v27 offset:1152
    ds_read_b64_tr_b16 v[58:59], v26 offset:41024
    v_mfma_f32_16x16x32_bf16 v[100:103], v[72:75], v[140:143], v[100:103]
    ds_read_b64_tr_b16 v[62:63], v27 offset:1216
    buffer_load_dwordx4 v4, s[12:15], s37 offen offset:1024 lds
    v_mfma_f32_16x16x32_bf16 v[112:115], v[32:35], v[36:39], 0
    v_mfma_f32_16x16x32_bf16 v[116:119], v[32:35], v[120:123], 0
    v_mfma_f32_16x16x32_bf16 v[112:115], v[40:43], v[44:47], v[112:115]
    v_mfma_f32_16x16x32_bf16 v[116:119], v[40:43], v[120:123], v[116:119]
    v_mfma_f32_16x16x32_bf16 v[104:107], v[76:79], v[136:139], v[104:107]
    v_mfma_f32_16x16x32_bf16 v[108:111], v[76:79], v[140:143], v[108:111]
    s_waitcnt vmcnt(4) lgkmcnt(0)
    s_barrier
    v_mfma_f32_16x16x32_bf16 v[96:99], v[80:83], v[144:147], v[96:99]
    s_cmp_eq_u32 s40, 1
    s_cbranch_scc0 Lskip_16
    v_mov_b32 v127, s46
    s_mov_b64 exec, 1
    buffer_store_dword v127, v2, s[16:19], s62 offen sc1
    s_mov_b64 exec, -1
Lskip_16:
    s_add_u32 m0, s63, 34816
    ds_read_b64_tr_b16 v[64:65], v6 offset:0
    v_mfma_f32_16x16x32_bf16 v[100:103], v[80:83], v[148:151], v[100:103]
    ds_read_b64_tr_b16 v[66:67], v6 offset:512
    ds_read_b64_tr_b16 v[68:69], v6 offset:1024
    ds_read_b64_tr_b16 v[70:71], v6 offset:1536
    v_mfma_f32_16x16x32_bf16 v[104:107], v[84:87], v[144:147], v[104:107]
    buffer_load_dwordx4 v4, s[8:11], s38 offen offset:0 lds
    v_mfma_f32_16x16x32_bf16 v[112:115], v[48:51], v[52:55], v[112:115]
    v_mfma_f32_16x16x32_bf16 v[116:119], v[48:51], v[120:123], v[116:119]
    v_mfma_f32_16x16x32_bf16 v[108:111], v[84:87], v[148:151], v[108:111]
    v_mfma_f32_16x16x32_bf16 v[112:115], v[56:59], v[60:63], v[112:115]
    v_mfma_f32_16x16x32_bf16 v[116:119], v[56:59], v[120:123], v[116:119]
    ds_read_b64_tr_b16 v[72:73], v6 offset:8192
    v_mfma_f32_16x16x32_bf16 v[96:99], v[88:91], v[152:155], v[96:99]
    ds_read_b64_tr_b16 v[74:75], v6 offset:8704
    ds_read_b64_tr_b16 v[76:77], v6 offset:9216
    ds_read_b64_tr_b16 v[78:79], v6 offset:9728
    v_mfma_f32_16x16x32_bf16 v[100:103], v[88:91], v[156:159], v[100:103]
    buffer_load_dwordx4 v4, s[12:15], s38 offen offset:1024 lds
    s_waitcnt vmcnt(6)
    buffer_store_dwordx4 v[112:115], v30, s[16:19], s60 offen sc1
    s_mov_b32 exec_lo, 0xf000f
    s_mov_b32 exec_hi, 0xf000f
    buffer_store_dwordx4 v[116:119], v30, s[16:19], s60 offen offset:256 sc1
    s_mov_b64 exec, -1
    v_mfma_f32_16x16x32_bf16 v[104:107], v[92:95], v[152:155], v[104:107]
    v_mfma_f32_16x16x32_bf16 v[108:111], v[92:95], v[156:159], v[108:111]
    s_waitcnt vmcnt(12) lgkmcnt(0)
    s_barrier
    v_mfma_f32_16x16x32_bf16 v[96:99], v[64:67], v[160:163], v[96:99]
    s_add_u32 m0, s63, 51200
    ds_read_b64_tr_b16 v[80:81], v6 offset:16384
    ds_read_b64_tr_b16 v[82:83], v6 offset:16896
    v_mfma_f32_16x16x32_bf16 v[100:103], v[64:67], v[164:167], v[100:103]
    ds_read_b64_tr_b16 v[84:85], v6 offset:17408
    ds_read_b64_tr_b16 v[86:87], v6 offset:17920
    buffer_load_dwordx4 v4, s[8:11], s39 offen offset:0 lds
    v_mfma_f32_16x16x32_bf16 v[104:107], v[68:71], v[160:163], v[104:107]
    ds_read2_b32 v[120:121], v28 offset0:0 offset1:64
    ds_read2_b32 v[122:123], v28 offset0:128 offset1:192
    v_mov_b32 v28, s46
    v_mfma_f32_16x16x32_bf16 v[108:111], v[68:71], v[164:167], v[108:111]
    ds_read_b64_tr_b16 v[88:89], v6 offset:24576
    ds_read_b64_tr_b16 v[90:91], v6 offset:25088
    ds_read_b64_tr_b16 v[92:93], v6 offset:25600
    v_mfma_f32_16x16x32_bf16 v[96:99], v[72:75], v[168:171], v[96:99]
    ds_read_b64_tr_b16 v[94:95], v6 offset:26112
    s_add_u32 s0, s63, 133120
    v_add_u32 v126, s0, v2
    v_mfma_f32_16x16x32_bf16 v[100:103], v[72:75], v[172:175], v[100:103]
    ds_read_b128 v[48:51], v126
    ds_read_b128 v[52:55], v126 offset:1024
    buffer_load_dwordx4 v4, s[12:15], s39 offen offset:1024 lds
    v_mfma_f32_16x16x32_bf16 v[104:107], v[76:79], v[168:171], v[104:107]
    v_mfma_f32_16x16x32_bf16 v[108:111], v[76:79], v[172:175], v[108:111]
    s_waitcnt vmcnt(12) lgkmcnt(0)
    s_barrier
    v_mfma_f32_16x16x32_bf16 v[96:99], v[80:83], v[176:179], v[96:99]
    v_and_b32 v4, 0x380, v2
    v_and_b32 v5, 0x70, v2
    v_mfma_f32_16x16x32_bf16 v[100:103], v[80:83], v[180:183], v[100:103]
    v_lshl_or_b32 v4, v4, 4, v5
    v_xor_b32 v5, 64, v4
    s_add_u32 m0, s63, 83968
    v_mfma_f32_16x16x32_bf16 v[104:107], v[84:87], v[176:179], v[104:107]
    ds_read_b64_tr_b16 v[64:65], v6 offset:32768
    ds_read_b64_tr_b16 v[66:67], v6 offset:33280
    v_mfma_f32_16x16x32_bf16 v[108:111], v[84:87], v[180:183], v[108:111]
    ds_read_b64_tr_b16 v[68:69], v6 offset:33792
    ds_read_b64_tr_b16 v[70:71], v6 offset:34304
    buffer_load_dwordx4 v4, s[20:23], s64 offen offset:0 lds
    v_mfma_f32_16x16x32_bf16 v[96:99], v[88:91], v[184:187], v[96:99]
    ds_read_b64_tr_b16 v[72:73], v6 offset:40960
    ds_read_b64_tr_b16 v[74:75], v6 offset:41472
    v_mfma_f32_16x16x32_bf16 v[100:103], v[88:91], v[188:191], v[100:103]
    ds_read_b64_tr_b16 v[76:77], v6 offset:41984
    ds_read_b64_tr_b16 v[78:79], v6 offset:42496
    buffer_load_dwordx4 v5, s[20:23], s64 offen offset:1024 lds
    v_mfma_f32_16x16x32_bf16 v[104:107], v[92:95], v[184:187], v[104:107]
    v_mfma_f32_16x16x32_bf16 v[108:111], v[92:95], v[188:191], v[108:111]
    s_waitcnt vmcnt(8) lgkmcnt(0)
    s_barrier
    v_mfma_f32_16x16x32_bf16 v[96:99], v[64:67], v[192:195], v[96:99]
    s_add_u32 m0, s63, 100352
    ds_read_b64_tr_b16 v[80:81], v124 offset:2048
    ds_read_b64_tr_b16 v[82:83], v124 offset:2560
    v_mfma_f32_16x16x32_bf16 v[100:103], v[64:67], v[196:199], v[100:103]
    ds_read_b64_tr_b16 v[84:85], v124 offset:3072
    ds_read_b64_tr_b16 v[86:87], v124 offset:3584
    buffer_load_dwordx4 v4, s[20:23], s65 offen offset:0 lds
    v_mfma_f32_16x16x32_bf16 v[104:107], v[68:71], v[192:195], v[104:107]
    v_add_f32 v120, v120, v121
    v_add_f32 v122, v122, v123
    v_add_f32 v120, v120, v122
    v_mfma_f32_16x16x32_bf16 v[108:111], v[68:71], v[196:199], v[108:111]
    v_mul_f32 v120, 0xbfb8aa3b, v120
    v_exp_f32 v120, v120
    s_nop 0
    v_mfma_f32_16x16x32_bf16 v[96:99], v[72:75], v[200:203], v[96:99]
    v_add_f32 v120, 1.0, v120
    v_rcp_f32 v0, v120
    ds_read_b64_tr_b16 v[88:89], v124 offset:10240
    v_mfma_f32_16x16x32_bf16 v[100:103], v[72:75], v[204:207], v[100:103]
    ds_read_b64_tr_b16 v[90:91], v124 offset:10752
    ds_read_b64_tr_b16 v[92:93], v124 offset:11264
    ds_read_b64_tr_b16 v[94:95], v124 offset:11776
    buffer_load_dwordx4 v5, s[20:23], s65 offen offset:1024 lds
    v_mfma_f32_16x16x32_bf16 v[104:107], v[76:79], v[200:203], v[104:107]
    v_mfma_f32_16x16x32_bf16 v[108:111], v[76:79], v[204:207], v[108:111]
    s_waitcnt vmcnt(8) lgkmcnt(0)
    s_barrier
    v_mfma_f32_16x16x32_bf16 v[96:99], v[80:83], v[208:211], v[96:99]
    s_mov_b64 exec, s[90:91]
    buffer_load_dword v31, v24, s[16:19], s85 offen sc1
    s_mov_b64 exec, -1
    s_add_u32 m0, s63, 116736
    v_mfma_f32_16x16x32_bf16 v[100:103], v[80:83], v[212:215], v[100:103]
    ds_read_b64_tr_b16 v[64:65], v124 offset:34816
    ds_read_b64_tr_b16 v[66:67], v124 offset:35328
    v_mfma_f32_16x16x32_bf16 v[104:107], v[84:87], v[208:211], v[104:107]
    ds_read_b64_tr_b16 v[68:69], v124 offset:35840
    ds_read_b64_tr_b16 v[70:71], v124 offset:36352
    v_mfma_f32_16x16x32_bf16 v[108:111], v[84:87], v[212:215], v[108:111]
    buffer_load_dwordx4 v4, s[20:23], s66 offen offset:0 lds
    ds_read_b64_tr_b16 v[72:73], v124 offset:43008
    v_mfma_f32_16x16x32_bf16 v[96:99], v[88:91], v[216:219], v[96:99]
    ds_read_b64_tr_b16 v[74:75], v124 offset:43520
    ds_read_b64_tr_b16 v[76:77], v124 offset:44032
    v_mfma_f32_16x16x32_bf16 v[100:103], v[88:91], v[220:223], v[100:103]
    ds_read_b64_tr_b16 v[78:79], v124 offset:44544
    buffer_load_dwordx4 v5, s[20:23], s66 offen offset:1024 lds
    v_mfma_f32_16x16x32_bf16 v[104:107], v[92:95], v[216:219], v[104:107]
    v_mfma_f32_16x16x32_bf16 v[108:111], v[92:95], v[220:223], v[108:111]
    s_waitcnt vmcnt(7) lgkmcnt(0)
    s_barrier
    v_mfma_f32_16x16x32_bf16 v[96:99], v[64:67], v[224:227], v[96:99]
    s_add_u32 m0, s63, 133120
    v_mfma_f32_16x16x32_bf16 v[100:103], v[64:67], v[228:231], v[100:103]
    ds_read_b64_tr_b16 v[80:81], v124 offset:51200
    ds_read_b64_tr_b16 v[82:83], v124 offset:51712
    v_mfma_f32_16x16x32_bf16 v[104:107], v[68:71], v[224:227], v[104:107]
    ds_read_b64_tr_b16 v[84:85], v124 offset:52224
    ds_read_b64_tr_b16 v[86:87], v124 offset:52736
    v_mfma_f32_16x16x32_bf16 v[108:111], v[68:71], v[228:231], v[108:111]
    buffer_load_dwordx4 v4, s[20:23], s67 offen offset:0 lds
    ds_read_b64_tr_b16 v[88:89], v124 offset:59392
    v_mfma_f32_16x16x32_bf16 v[96:99], v[72:75], v[232:235], v[96:99]
    ds_read_b64_tr_b16 v[90:91], v124 offset:59904
    ds_read_b64_tr_b16 v[92:93], v124 offset:60416
    v_mfma_f32_16x16x32_bf16 v[100:103], v[72:75], v[236:239], v[100:103]
    ds_read_b64_tr_b16 v[94:95], v124 offset:60928
    buffer_load_dwordx4 v5, s[20:23], s67 offen offset:1024 lds
    v_mfma_f32_16x16x32_bf16 v[104:107], v[76:79], v[232:235], v[104:107]
    v_mfma_f32_16x16x32_bf16 v[108:111], v[76:79], v[236:239], v[108:111]
    s_waitcnt lgkmcnt(0)
    s_barrier
    v_mfma_f32_16x16x32_bf16 v[96:99], v[80:83], v[240:243], v[96:99]
    s_mov_b64 exec, s[90:91]
    s_waitcnt vmcnt(4)
    v_cmp_ne_u32 vcc, v28, v31
    s_cbranch_vccnz Lpoll_17
Lpd_18:
    s_mov_b64 exec, -1
    v_mfma_f32_16x16x32_bf16 v[100:103], v[80:83], v[244:247], v[100:103]
    s_add_u32 m0, s63, 67584
    s_nop 0
    buffer_load_dwordx4 v2, s[4:7], s69 offen offset:0 sc1 lds
    v_mfma_f32_16x16x32_bf16 v[104:107], v[84:87], v[240:243], v[104:107]
    buffer_load_dwordx4 v2, s[4:7], s69 offen offset:1024 sc1 lds
    s_add_u32 m0, s1, 32768
    v_mfma_f32_16x16x32_bf16 v[108:111], v[84:87], v[244:247], v[108:111]
    v_add_u32 v3, s86, v2
    v_mfma_f32_16x16x32_bf16 v[96:99], v[88:91], v[248:251], v[96:99]
    buffer_load_dwordx4 v3, s[4:7], 0 offen offset:0 sc1 lds
    buffer_load_dwordx4 v3, s[4:7], 0 offen offset:1024 sc1 lds
    v_mfma_f32_16x16x32_bf16 v[100:103], v[88:91], v[252:255], v[100:103]
    buffer_load_dwordx4 v3, s[4:7], 0 offen offset:2048 sc1 lds
    buffer_load_dwordx4 v3, s[4:7], 0 offen offset:3072 sc1 lds
    v_mfma_f32_16x16x32_bf16 v[104:107], v[92:95], v[248:251], v[104:107]
    v_mfma_f32_16x16x32_bf16 v[108:111], v[92:95], v[252:255], v[108:111]
    v_mov_b32 v112, 0x3eb8aa3b
    s_nop 4
    v_cvt_pk_bf16_f32 v96, v96, v97
    v_cvt_pk_bf16_f32 v97, v98, v99
    v_cvt_pk_bf16_f32 v98, v100, v101
    v_cvt_pk_bf16_f32 v99, v102, v103
    v_mul_f32 v104, v104, v112
    v_mul_f32 v105, v105, v112
    v_permlane16_swap_b32 v96, v98
    v_permlane16_swap_b32 v97, v99
    v_mul_f32 v106, v106, v112
    v_mul_f32 v107, v107, v112
    v_mfma_f32_32x32x16_bf16 v[32:47], v[12:15], v[96:99], 0
    v_mul_f32 v108, v108, v112
    v_mul_f32 v109, v109, v112
    v_mul_f32 v110, v110, v112
    v_mul_f32 v111, v111, v112
    v_cvt_pk_bf16_f32 v8, v104, v105
    v_cvt_pk_bf16_f32 v9, v106, v107
    v_cvt_pk_bf16_f32 v10, v108, v109
    v_cvt_pk_bf16_f32 v11, v110, v111
    s_nop 0
    v_permlane16_swap_b32 v8, v10
    v_permlane16_swap_b32 v9, v11
    s_nop 0
    v_max3_f32 v113, v32, v33, v34
    v_max3_f32 v114, v35, v36, v37
    v_max3_f32 v115, v38, v39, v40
    v_max3_f32 v116, v41, v42, v43
    v_max3_f32 v117, v44, v45, v46
    v_mov_b32 v112, 0x3fb8aa3b
    v_max3_f32 v113, v113, v114, v47
    v_max3_f32 v115, v115, v116, v117
    v_max_f32 v113, v113, v115
    v_mul_f32 v114, v112, v113
    v_pk_fma_f32 v[32:33], v[32:33], v[112:113], v[114:115] op_sel_hi:[1,0,0] neg_lo:[0,0,1] neg_hi:[0,0,1]
    v_pk_fma_f32 v[34:35], v[34:35], v[112:113], v[114:115] op_sel_hi:[1,0,0] neg_lo:[0,0,1] neg_hi:[0,0,1]
    v_pk_fma_f32 v[36:37], v[36:37], v[112:113], v[114:115] op_sel_hi:[1,0,0] neg_lo:[0,0,1] neg_hi:[0,0,1]
    v_pk_fma_f32 v[38:39], v[38:39], v[112:113], v[114:115] op_sel_hi:[1,0,0] neg_lo:[0,0,1] neg_hi:[0,0,1]
    v_pk_fma_f32 v[40:41], v[40:41], v[112:113], v[114:115] op_sel_hi:[1,0,0] neg_lo:[0,0,1] neg_hi:[0,0,1]
    v_pk_fma_f32 v[42:43], v[42:43], v[112:113], v[114:115] op_sel_hi:[1,0,0] neg_lo:[0,0,1] neg_hi:[0,0,1]
    v_pk_fma_f32 v[44:45], v[44:45], v[112:113], v[114:115] op_sel_hi:[1,0,0] neg_lo:[0,0,1] neg_hi:[0,0,1]
    v_pk_fma_f32 v[46:47], v[46:47], v[112:113], v[114:115] op_sel_hi:[1,0,0] neg_lo:[0,0,1] neg_hi:[0,0,1]
    v_exp_f32 v32, v32
    v_exp_f32 v33, v33
    v_exp_f32 v34, v34
    v_exp_f32 v35, v35
    v_exp_f32 v36, v36
    v_pk_add_f32 v[112:113], v[32:33], v[34:35]
    v_exp_f32 v37, v37
    v_exp_f32 v38, v38
    v_pk_add_f32 v[112:113], v[112:113], v[36:37]
    v_exp_f32 v39, v39
    v_exp_f32 v40, v40
    v_pk_add_f32 v[112:113], v[112:113], v[38:39]
    v_exp_f32 v41, v41
    v_exp_f32 v42, v42
    v_pk_add_f32 v[112:113], v[112:113], v[40:41]
    v_exp_f32 v43, v43
    v_exp_f32 v44, v44
    v_pk_add_f32 v[112:113], v[112:113], v[42:43]
    v_exp_f32 v45, v45
    v_exp_f32 v46, v46
    v_pk_add_f32 v[112:113], v[112:113], v[44:45]
    v_exp_f32 v47, v47
    s_nop 0
    v_pk_add_f32 v[112:113], v[112:113], v[46:47]
    v_add_f32 v112, v112, v113
    v_rcp_f32 v112, v112
    s_nop 0
    v_pk_mul_f32 v[32:33], v[32:33], v[112:113] op_sel_hi:[1,0]
    v_pk_mul_f32 v[34:35], v[34:35], v[112:113] op_sel_hi:[1,0]
    v_pk_mul_f32 v[36:37], v[36:37], v[112:113] op_sel_hi:[1,0]
    v_pk_mul_f32 v[38:39], v[38:39], v[112:113] op_sel_hi:[1,0]
    v_pk_mul_f32 v[40:41], v[40:41], v[112:113] op_sel_hi:[1,0]
    v_pk_mul_f32 v[42:43], v[42:43], v[112:113] op_sel_hi:[1,0]
    v_pk_mul_f32 v[44:45], v[44:45], v[112:113] op_sel_hi:[1,0]
    v_pk_mul_f32 v[46:47], v[46:47], v[112:113] op_sel_hi:[1,0]
    v_cvt_pk_bf16_f32 v64, v32, v33
    v_cvt_pk_bf16_f32 v65, v34, v35
    v_cvt_pk_bf16_f32 v66, v36, v37
    v_cvt_pk_bf16_f32 v67, v38, v39
    v_cvt_pk_bf16_f32 v68, v40, v41
    v_cvt_pk_bf16_f32 v69, v42, v43
    v_cvt_pk_bf16_f32 v70, v44, v45
    v_cvt_pk_bf16_f32 v71, v46, v47
    s_waitcnt vmcnt(4) lgkmcnt(0)
    s_barrier
    s_cmp_eq_u32 s40, 1
    s_cbranch_scc0 Lskip_19
    v_mov_b32 v127, s46
    s_mov_b64 exec, 1
    buffer_store_dword v127, v2, s[16:19], s49 offen sc1
    s_mov_b64 exec, -1
Lskip_19:
L_merge:
    ds_read_b128 v[248:251], v29
    ds_read_b64_tr_b16 v[80:81], v49 offset:0
    ds_read_b64_tr_b16 v[82:83], v49 offset:128
    ds_read_b64_tr_b16 v[84:85], v49 offset:256
    ds_read_b64_tr_b16 v[86:87], v49 offset:384
    v_sub_u32 v49, v49, v50
    s_mov_b64 exec, 3
    buffer_load_dword v58, v24, s[16:19], s84 offen sc1
    s_mov_b64 exec, -1
    ds_read_b64_tr_b16 v[128:129], v53 offset:0
    ds_read_b64_tr_b16 v[130:131], v53 offset:256
    ds_read_b64_tr_b16 v[132:133], v54 offset:0
    ds_read_b64_tr_b16 v[134:135], v54 offset:256
    ds_read_b64_tr_b16 v[136:137], v53 offset:2048
    ds_read_b64_tr_b16 v[138:139], v53 offset:2304
    ds_read_b64_tr_b16 v[140:141], v54 offset:2048
    ds_read_b64_tr_b16 v[142:143], v54 offset:2304
    s_waitcnt lgkmcnt(12)
    v_mfma_f32_32x32x16_bf16 v[192:207], v[248:251], v[8:11], 0
    s_waitcnt lgkmcnt(6)
    ds_read_b64_tr_b16 v[144:145], v53 offset:4096
    ds_read_b64_tr_b16 v[146:147], v53 offset:4352
    ds_read_b64_tr_b16 v[148:149], v54 offset:4096
    ds_read_b64_tr_b16 v[150:151], v54 offset:4352
    ds_read_b64_tr_b16 v[152:153], v53 offset:6144
    ds_read_b64_tr_b16 v[154:155], v53 offset:6400
    ds_read_b64_tr_b16 v[156:157], v54 offset:6144
    ds_read_b64_tr_b16 v[158:159], v54 offset:6400
    s_mov_b32 m0, s1
    v_add_u32 v3, s68, v2
    buffer_load_dwordx4 v3, s[4:7], 0 offen offset:0 sc1 lds
    v_exp_f32 v192, v192
    s_waitcnt lgkmcnt(6)
    ds_read_b64_tr_b16 v[160:161], v53 offset:8192
    v_exp_f32 v193, v193
    ds_read_b64_tr_b16 v[162:163], v53 offset:8448
    v_exp_f32 v194, v194
    ds_read_b64_tr_b16 v[164:165], v54 offset:8192
    v_exp_f32 v195, v195
    buffer_load_dwordx4 v3, s[4:7], 0 offen offset:1024 sc1 lds
    ds_read_b64_tr_b16 v[166:167], v54 offset:8448
    v_exp_f32 v196, v196
    ds_read_b64_tr_b16 v[168:169], v53 offset:10240
    v_exp_f32 v197, v197
    ds_read_b64_tr_b16 v[170:171], v53 offset:10496
    v_exp_f32 v198, v198
    ds_read_b64_tr_b16 v[172:173], v54 offset:10240
    v_exp_f32 v199, v199
    buffer_load_dwordx4 v3, s[4:7], 0 offen offset:2048 sc1 lds
    ds_read_b64_tr_b16 v[174:175], v54 offset:10496
    v_exp_f32 v200, v200
    s_waitcnt lgkmcnt(6)
    ds_read_b64_tr_b16 v[176:177], v53 offset:12288
    v_exp_f32 v201, v201
    ds_read_b64_tr_b16 v[178:179], v53 offset:12544
    v_exp_f32 v202, v202
    ds_read_b64_tr_b16 v[180:181], v54 offset:12288
    v_exp_f32 v203, v203
    buffer_load_dwordx4 v3, s[4:7], 0 offen offset:3072 sc1 lds
    ds_read_b64_tr_b16 v[182:183], v54 offset:12544
    v_exp_f32 v204, v204
    ds_read_b64_tr_b16 v[184:185], v53 offset:14336
    v_exp_f32 v205, v205
    ds_read_b64_tr_b16 v[186:187], v53 offset:14592
    v_exp_f32 v206, v206
    ds_read_b64_tr_b16 v[188:189], v54 offset:14336
    v_exp_f32 v207, v207
    ds_read_b64_tr_b16 v[190:191], v54 offset:14592
    v_cvt_pk_bf16_f32 v240, v192, v193
    v_cvt_pk_bf16_f32 v241, v194, v195
    v_cvt_pk_bf16_f32 v242, v196, v197
    v_cvt_pk_bf16_f32 v243, v198, v199
    v_cvt_pk_bf16_f32 v244, v200, v201
    v_cvt_pk_bf16_f32 v245, v202, v203
    v_cvt_pk_bf16_f32 v246, v204, v205
    v_cvt_pk_bf16_f32 v247, v206, v207
    v_and_b32 v240, v240, v16
    v_and_b32 v241, v241, v17
    v_and_b32 v242, v242, v18
    v_and_b32 v243, v243, v19
    v_and_b32 v244, v244, v20
    v_and_b32 v245, v245, v21
    v_and_b32 v246, v246, v22
    v_and_b32 v247, v247, v23
    v_not_b32 v16, v16
    v_not_b32 v17, v17
    v_not_b32 v18, v18
    v_not_b32 v19, v19
    v_not_b32 v20, v20
    v_not_b32 v21, v21
    v_not_b32 v22, v22
    v_not_b32 v23, v23
    v_mfma_f32_32x32x16_bf16 v[224:239], v[80:83], v[240:243], 0
    v_mfma_f32_32x32x16_bf16 v[224:239], v[84:87], v[244:247], v[224:239]
    s_mov_b64 exec, 3
    s_waitcnt vmcnt(4)
    v_cmp_ne_u32 vcc, v28, v58
    s_cbranch_vccnz Lpoll_20
Lpd_21:
    s_mov_b64 exec, -1
    s_waitcnt vmcnt(4) lgkmcnt(0)
    s_barrier
    ds_read_b128 v[248:251], v48 offset:57344
    ds_read_b128 v[252:255], v48 offset:49152
    ds_read_b64_tr_b16 v[88:89], v49 offset:0
    ds_read_b64_tr_b16 v[90:91], v49 offset:128
    ds_read_b64_tr_b16 v[92:93], v49 offset:256
    ds_read_b64_tr_b16 v[94:95], v49 offset:384
    s_setprio 1
    s_cmp_ge_u32 s40, 4
    s_cbranch_scc0 Lskip_22
    s_setprio 2
Lskip_22:
    s_waitcnt lgkmcnt(5)
    v_mfma_f32_32x32x16_bf16 v[208:223], v[248:251], v[8:11], 0
    buffer_load_dwordx2 v[72:73], v52, s[16:19], s87 offen offset:0 sc1
    buffer_load_dwordx2 v[74:75], v52, s[16:19], s87 offen offset:256 sc1
    buffer_load_dwordx2 v[76:77], v52, s[16:19], s87 offen offset:512 sc1
    buffer_load_dwordx2 v[78:79], v52, s[16:19], s87 offen offset:768 sc1
    s_nop 5
    s_cmp_lt_u32 s48, 1
    s_cbranch_scc1 L_ex7
    v_exp_f32 v208, v208
    v_exp_f32 v209, v209
    s_mov_b64 exec, 3
    buffer_load_dword v56, v24, s[16:19], s88 offen sc1
    s_mov_b64 exec, -1
    v_exp_f32 v210, v210
    v_exp_f32 v211, v211
    s_add_u32 m0, s63, 83968
    s_nop 0
    v_exp_f32 v212, v212
    v_exp_f32 v213, v213
    s_waitcnt lgkmcnt(0)
    v_exp_f32 v214, v214
    v_exp_f32 v215, v215
    v_mfma_f32_32x32x16_bf16 v[192:207], v[252:255], v[8:11], 0
    ds_read_b128 v[248:251], v48 offset:40960
    v_sub_u32 v49, v49, v50
    v_cvt_pk_bf16_f32 v240, v208, v209
    v_cvt_pk_bf16_f32 v241, v210, v211
    v_exp_f32 v216, v216
    v_exp_f32 v217, v217
    v_cvt_pk_bf16_f32 v242, v212, v213
    v_cvt_pk_bf16_f32 v243, v214, v215
    v_exp_f32 v218, v218
    v_exp_f32 v219, v219
    ds_read_b64_tr_b16 v[80:81], v49 offset:0
    ds_read_b64_tr_b16 v[82:83], v49 offset:128
    ds_read_b64_tr_b16 v[84:85], v49 offset:256
    ds_read_b64_tr_b16 v[86:87], v49 offset:384
    v_exp_f32 v220, v220
    v_mfma_f32_32x32x16_bf16 v[224:239], v[88:91], v[240:243], v[224:239]
    v_exp_f32 v221, v221
    v_exp_f32 v222, v222
    v_exp_f32 v223, v223
    v_cvt_pk_bf16_f32 v244, v216, v217
    v_cvt_pk_bf16_f32 v245, v218, v219
    v_cvt_pk_bf16_f32 v246, v220, v221
    v_cvt_pk_bf16_f32 v247, v222, v223
    v_exp_f32 v192, v192
    v_exp_f32 v193, v193
    v_mfma_f32_32x32x16_bf16 v[224:239], v[92:95], v[244:247], v[224:239]
    s_cmp_lt_u32 s48, 2
    s_cbranch_scc1 L_ex6
    s_setprio 1
    v_exp_f32 v194, v194
    v_exp_f32 v195, v195
    buffer_load_dwordx4 v4, s[24:27], s64 offen offset:0 lds
    v_exp_f32 v196, v196
    v_exp_f32 v197, v197
    s_waitcnt vmcnt(2)
    v_max3_u32 v120, v72, v74, v76
    v_max_u32 v120, v120, v78
    v_cmp_eq_u32 vcc, -1, v120
    s_cbranch_vccnz Lkv_23
Lkvd_24:
    v_mfma_f32_32x32x16_bf16 v[96:111], v[72:75], v[64:67], 0
    v_mfma_f32_32x32x16_bf16 v[96:111], v[76:79], v[68:71], v[96:111]
    s_waitcnt lgkmcnt(0)
    v_exp_f32 v198, v198
    v_exp_f32 v199, v199
    v_mfma_f32_32x32x16_bf16 v[208:223], v[248:251], v[8:11], 0
    ds_read_b128 v[252:255], v48 offset:32768
    v_sub_u32 v49, v49, v50
    v_cvt_pk_bf16_f32 v240, v192, v193
    v_cvt_pk_bf16_f32 v241, v194, v195
    v_exp_f32 v200, v200
    v_exp_f32 v201, v201
    v_cvt_pk_bf16_f32 v242, v196, v197
    v_cvt_pk_bf16_f32 v243, v198, v199
    v_exp_f32 v202, v202
    v_exp_f32 v203, v203
    ds_read_b64_tr_b16 v[88:89], v49 offset:0
    ds_read_b64_tr_b16 v[90:91], v49 offset:128
    ds_read_b64_tr_b16 v[92:93], v49 offset:256
    ds_read_b64_tr_b16 v[94:95], v49 offset:384
    v_exp_f32 v204, v204
    v_add_f32 v120, 0x358637bd, v104
    v_rcp_f32 v120, v120
    v_mfma_f32_32x32x16_bf16 v[224:239], v[80:83], v[240:243], v[224:239]
    buffer_load_dwordx4 v5, s[24:27], s64 offen offset:1024 lds
    s_add_u32 m0, s63, 100352
    v_exp_f32 v205, v205
    v_exp_f32 v206, v206
    v_exp_f32 v207, v207
    v_mul_f32 v120, v120, v0
    v_mul_f32 v96, v96, v120
    v_mul_f32 v97, v97, v120
    v_mul_f32 v98, v98, v120
    v_mul_f32 v99, v99, v120
    v_mul_f32 v100, v100, v120
    v_mul_f32 v101, v101, v120
    v_mul_f32 v102, v102, v120
    v_mul_f32 v103, v103, v120
    v_cvt_pk_bf16_f32 v112, v96, v97
    v_cvt_pk_bf16_f32 v113, v98, v99
    v_cvt_pk_bf16_f32 v114, v100, v101
    v_cvt_pk_bf16_f32 v115, v102, v103
    buffer_store_dwordx4 v[112:115], v2, s[16:19], s56 offen sc1
    v_cvt_pk_bf16_f32 v244, v200, v201
    v_cvt_pk_bf16_f32 v245, v202, v203
    v_cvt_pk_bf16_f32 v246, v204, v205
    v_cvt_pk_bf16_f32 v247, v206, v207
    v_exp_f32 v208, v208
    v_exp_f32 v209, v209
    v_mfma_f32_32x32x16_bf16 v[224:239], v[84:87], v[244:247], v[224:239]
    s_cmp_lt_u32 s48, 3
    s_cbranch_scc1 L_ex5
    s_cmp_ge_u32 s40, 4
    s_cbranch_scc0 Lskip_25
    s_setprio 2
Lskip_25:
    s_waitcnt vmcnt(8)
    s_barrier
    v_exp_f32 v210, v210
    v_exp_f32 v211, v211
    buffer_load_dwordx4 v4, s[24:27], s65 offen offset:0 lds
    v_exp_f32 v212, v212
    v_exp_f32 v213, v213
    s_waitcnt lgkmcnt(0)
    v_exp_f32 v214, v214
    v_exp_f32 v215, v215
    v_mfma_f32_32x32x16_bf16 v[192:207], v[252:255], v[8:11], 0
    ds_read_b128 v[248:251], v48 offset:24576
    v_sub_u32 v49, v49, v50
    v_cvt_pk_bf16_f32 v240, v208, v209
    v_cvt_pk_bf16_f32 v241, v210, v211
    v_exp_f32 v216, v216
    v_exp_f32 v217, v217
    v_cvt_pk_bf16_f32 v242, v212, v213
    v_cvt_pk_bf16_f32 v243, v214, v215
    v_exp_f32 v218, v218
    v_exp_f32 v219, v219
    ds_read_b64_tr_b16 v[80:81], v49 offset:0
    ds_read_b64_tr_b16 v[82:83], v49 offset:128
    ds_read_b64_tr_b16 v[84:85], v49 offset:256
    ds_read_b64_tr_b16 v[86:87], v49 offset:384
    v_exp_f32 v220, v220
    v_mfma_f32_32x32x16_bf16 v[224:239], v[88:91], v[240:243], v[224:239]
    buffer_load_dwordx4 v5, s[24:27], s65 offen offset:1024 lds
    s_add_u32 m0, s63, 116736
    v_exp_f32 v221, v221
    v_exp_f32 v222, v222
    v_exp_f32 v223, v223
    v_cvt_pk_bf16_f32 v244, v216, v217
    v_cvt_pk_bf16_f32 v245, v218, v219
    v_cvt_pk_bf16_f32 v246, v220, v221
    v_cvt_pk_bf16_f32 v247, v222, v223
    v_exp_f32 v192, v192
    v_exp_f32 v193, v193
    v_mfma_f32_32x32x16_bf16 v[224:239], v[92:95], v[244:247], v[224:239]
    s_cmp_lt_u32 s48, 4
    s_cbranch_scc1 L_ex4
    s_mov_b64 exec, 3
    s_waitcnt vmcnt(5)
    v_cmp_ne_u32 vcc, v28, v56
    s_cbranch_vccnz Lpoll_26
Lpd_27:
    s_mov_b64 exec, -1
    v_exp_f32 v194, v194
    v_exp_f32 v195, v195
    buffer_load_dwordx4 v4, s[24:27], s66 offen offset:0 lds
    v_exp_f32 v196, v196
    v_exp_f32 v197, v197
    s_waitcnt lgkmcnt(0)
    v_exp_f32 v198, v198
    v_exp_f32 v199, v199
    v_mfma_f32_32x32x16_bf16 v[208:223], v[248:251], v[8:11], 0
    ds_read_b128 v[252:255], v48 offset:16384
    v_sub_u32 v49, v49, v50
    v_cvt_pk_bf16_f32 v240, v192, v193
    v_cvt_pk_bf16_f32 v241, v194, v195
    v_exp_f32 v200, v200
    v_exp_f32 v201, v201
    v_cvt_pk_bf16_f32 v242, v196, v197
    v_cvt_pk_bf16_f32 v243, v198, v199
    v_exp_f32 v202, v202
    v_exp_f32 v203, v203
    ds_read_b64_tr_b16 v[88:89], v49 offset:0
    ds_read_b64_tr_b16 v[90:91], v49 offset:128
    ds_read_b64_tr_b16 v[92:93], v49 offset:256
    ds_read_b64_tr_b16 v[94:95], v49 offset:384
    v_exp_f32 v204, v204
    v_mfma_f32_32x32x16_bf16 v[224:239], v[80:83], v[240:243], v[224:239]
    buffer_load_dwordx4 v5, s[24:27], s66 offen offset:1024 lds
    s_add_u32 m0, s63, 133120
    v_exp_f32 v205, v205
    v_exp_f32 v206, v206
    v_exp_f32 v207, v207
    v_cvt_pk_bf16_f32 v244, v200, v201
    v_cvt_pk_bf16_f32 v245, v202, v203
    v_cvt_pk_bf16_f32 v246, v204, v205
    v_cvt_pk_bf16_f32 v247, v206, v207
    v_exp_f32 v208, v208
    v_exp_f32 v209, v209
    v_mfma_f32_32x32x16_bf16 v[224:239], v[84:87], v[244:247], v[224:239]
    s_cmp_lt_u32 s48, 5
    s_cbranch_scc1 L_ex3
    s_setprio 1
    v_exp_f32 v210, v210
    v_exp_f32 v211, v211
    buffer_load_dwordx4 v4, s[24:27], s67 offen offset:0 lds
    v_exp_f32 v212, v212
    v_exp_f32 v213, v213
    s_waitcnt lgkmcnt(0)
    v_exp_f32 v214, v214
    v_exp_f32 v215, v215
    v_mfma_f32_32x32x16_bf16 v[192:207], v[252:255], v[8:11], 0
    ds_read_b128 v[248:251], v48 offset:8192
    v_sub_u32 v49, v49, v50
    v_cvt_pk_bf16_f32 v240, v208, v209
    v_cvt_pk_bf16_f32 v241, v210, v211
    v_exp_f32 v216, v216
    v_exp_f32 v217, v217
    v_cvt_pk_bf16_f32 v242, v212, v213
    v_cvt_pk_bf16_f32 v243, v214, v215
    v_exp_f32 v218, v218
    v_exp_f32 v219, v219
    ds_read_b64_tr_b16 v[80:81], v49 offset:0
    ds_read_b64_tr_b16 v[82:83], v49 offset:128
    ds_read_b64_tr_b16 v[84:85], v49 offset:256
    ds_read_b64_tr_b16 v[86:87], v49 offset:384
    v_exp_f32 v220, v220
    v_mfma_f32_32x32x16_bf16 v[224:239], v[88:91], v[240:243], v[224:239]
    buffer_load_dwordx4 v5, s[24:27], s67 offen offset:1024 lds
    v_exp_f32 v221, v221
    v_exp_f32 v222, v222
    v_exp_f32 v223, v223
    v_cvt_pk_bf16_f32 v244, v216, v217
    v_cvt_pk_bf16_f32 v245, v218, v219
    v_cvt_pk_bf16_f32 v246, v220, v221
    v_cvt_pk_bf16_f32 v247, v222, v223
    v_exp_f32 v192, v192
    v_exp_f32 v193, v193
    v_mfma_f32_32x32x16_bf16 v[224:239], v[92:95], v[244:247], v[224:239]
    s_cmp_lt_u32 s48, 6
    s_cbranch_scc1 L_ex2
    s_cmp_ge_u32 s40, 4
    s_cbranch_scc0 Lskip_28
    s_setprio 2
Lskip_28:
    v_exp_f32 v194, v194
    v_exp_f32 v195, v195
    buffer_load_dwordx4 v[96:99], v2, s[16:19], s72 offen offset:0 sc1
    v_exp_f32 v196, v196
    v_exp_f32 v197, v197
    s_waitcnt lgkmcnt(0)
    v_exp_f32 v198, v198
    v_exp_f32 v199, v199
    v_mfma_f32_32x32x16_bf16 v[208:223], v[248:251], v[8:11], 0
    ds_read_b128 v[252:255], v48 offset:0
    v_sub_u32 v49, v49, v50
    v_cvt_pk_bf16_f32 v240, v192, v193
    v_cvt_pk_bf16_f32 v241, v194, v195
    buffer_load_dwordx4 v[100:103], v2, s[16:19], s72 offen offset:1024 sc1
    v_exp_f32 v200, v200
    v_exp_f32 v201, v201
    v_cvt_pk_bf16_f32 v242, v196, v197
    v_cvt_pk_bf16_f32 v243, v198, v199
    v_exp_f32 v202, v202
    v_exp_f32 v203, v203
    ds_read_b64_tr_b16 v[88:89], v49 offset:0
    ds_read_b64_tr_b16 v[90:91], v49 offset:128
    ds_read_b64_tr_b16 v[92:93], v49 offset:256
    ds_read_b64_tr_b16 v[94:95], v49 offset:384
    v_exp_f32 v204, v204
    v_mfma_f32_32x32x16_bf16 v[224:239], v[80:83], v[240:243], v[224:239]
    buffer_load_dwordx4 v[104:107], v2, s[16:19], s72 offen offset:2048 sc1
    v_exp_f32 v205, v205
    v_exp_f32 v206, v206
    v_exp_f32 v207, v207
    v_cvt_pk_bf16_f32 v244, v200, v201
    v_cvt_pk_bf16_f32 v245, v202, v203
    buffer_load_dwordx4 v[108:111], v2, s[16:19], s72 offen offset:3072 sc1
    v_cvt_pk_bf16_f32 v246, v204, v205
    v_cvt_pk_bf16_f32 v247, v206, v207
    v_exp_f32 v208, v208
    v_exp_f32 v209, v209
    v_mfma_f32_32x32x16_bf16 v[224:239], v[84:87], v[244:247], v[224:239]
    s_cmp_lt_u32 s48, 7
    s_cbranch_scc1 L_ex1
    v_exp_f32 v210, v210
    v_exp_f32 v211, v211
    buffer_load_dwordx4 v[112:115], v2, s[16:19], s73 offen offset:0 sc1
    v_exp_f32 v212, v212
    v_exp_f32 v213, v213
    s_waitcnt lgkmcnt(0)
    v_exp_f32 v214, v214
    v_exp_f32 v215, v215
    v_mfma_f32_32x32x16_bf16 v[192:207], v[252:255], v[8:11], 0
    v_sub_u32 v49, v49, v50
    v_cvt_pk_bf16_f32 v240, v208, v209
    v_cvt_pk_bf16_f32 v241, v210, v211
    buffer_load_dwordx4 v[116:119], v2, s[16:19], s73 offen offset:1024 sc1
    v_exp_f32 v216, v216
    v_exp_f32 v217, v217
    v_cvt_pk_bf16_f32 v242, v212, v213
    v_cvt_pk_bf16_f32 v243, v214, v215
    v_exp_f32 v218, v218
    v_exp_f32 v219, v219
    ds_read_b64_tr_b16 v[80:81], v49 offset:0
    ds_read_b64_tr_b16 v[82:83], v49 offset:128
    ds_read_b64_tr_b16 v[84:85], v49 offset:256
    ds_read_b64_tr_b16 v[86:87], v49 offset:384
    v_exp_f32 v220, v220
    v_mfma_f32_32x32x16_bf16 v[224:239], v[88:91], v[240:243], v[224:239]
    buffer_load_dwordx4 v[120:123], v2, s[16:19], s73 offen offset:2048 sc1
    v_exp_f32 v221, v221
    v_exp_f32 v222, v222
    v_exp_f32 v223, v223
    v_cvt_pk_bf16_f32 v244, v216, v217
    v_cvt_pk_bf16_f32 v245, v218, v219
    buffer_load_dwordx4 v[124:127], v2, s[16:19], s73 offen offset:3072 sc1
    v_cvt_pk_bf16_f32 v246, v220, v221
    v_cvt_pk_bf16_f32 v247, v222, v223
    v_exp_f32 v192, v192
    v_exp_f32 v193, v193
    v_mfma_f32_32x32x16_bf16 v[224:239], v[92:95], v[244:247], v[224:239]
    s_cmp_lt_u32 s48, 8
    s_cbranch_scc1 L_ex0
    s_setprio 1
    v_exp_f32 v194, v194
    v_exp_f32 v195, v195
    v_exp_f32 v196, v196
    v_exp_f32 v197, v197
    s_waitcnt lgkmcnt(0)
    v_exp_f32 v198, v198
    v_exp_f32 v199, v199
    v_cvt_pk_bf16_f32 v240, v192, v193
    v_cvt_pk_bf16_f32 v241, v194, v195
    v_exp_f32 v200, v200
    v_exp_f32 v201, v201
    v_cvt_pk_bf16_f32 v242, v196, v197
    v_cvt_pk_bf16_f32 v243, v198, v199
    v_and_b32 v240, v240, v16
    v_and_b32 v241, v241, v17
    v_exp_f32 v202, v202
    v_and_b32 v242, v242, v18
    v_and_b32 v243, v243, v19
    v_exp_f32 v203, v203
    v_exp_f32 v204, v204
    v_mfma_f32_32x32x16_bf16 v[224:239], v[80:83], v[240:243], v[224:239]
    v_exp_f32 v205, v205
    v_exp_f32 v206, v206
    v_exp_f32 v207, v207
    v_cvt_pk_bf16_f32 v244, v200, v201
    v_cvt_pk_bf16_f32 v245, v202, v203
    v_cvt_pk_bf16_f32 v246, v204, v205
    v_cvt_pk_bf16_f32 v247, v206, v207
    v_and_b32 v244, v244, v20
    v_and_b32 v245, v245, v21
    v_and_b32 v246, v246, v22
    v_and_b32 v247, v247, v23
    s_nop 1
    v_mfma_f32_32x32x16_bf16 v[224:239], v[84:87], v[244:247], v[224:239]
L_attn_end:
    v_sub_f32 v25, 1.0, v0
    v_mov_b32 v12, v53
    v_mov_b32 v13, v54
    s_nop 8
    v_cmp_lt_f32 vcc, 0x1f800000, v232
    v_rcp_f32 v24, v232
    s_mov_b64 s[58:59], vcc
    v_cmp_gt_f32 vcc, 0x5f800000, v232
    s_nop 1
    s_and_b64 s[58:59], s[58:59], vcc
    s_cmp_eq_u64 s[58:59], -1
    s_cbranch_scc0 L_maxpath
L_attn_ok:
    v_mul_f32 v24, v24, v25
    v_pk_mul_f32 v[224:225], v[224:225], v[24:25] op_sel_hi:[1,0]
    v_pk_mul_f32 v[226:227], v[226:227], v[24:25] op_sel_hi:[1,0]
    v_pk_mul_f32 v[228:229], v[228:229], v[24:25] op_sel_hi:[1,0]
    v_pk_mul_f32 v[230:231], v[230:231], v[24:25] op_sel_hi:[1,0]
    v_cvt_pk_bf16_f32 v8, v224, v225
    v_cvt_pk_bf16_f32 v9, v226, v227
    v_cvt_pk_bf16_f32 v10, v228, v229
    v_cvt_pk_bf16_f32 v11, v230, v231
    buffer_store_dwordx4 v[8:11], v2, s[16:19], s57 offen sc1
    s_setprio 0
    s_mov_b32 s53, 0
    s_waitcnt vmcnt(8)
L_ob0:
    v_cmp_eq_u32 vcc, -1, v96
    s_cbranch_vccnz L_obre0
L_obok0:
    v_mfma_f32_32x32x16_bf16 v[32:47], v[128:131], v[96:99], 0
    v_and_b32 v24, 31, v1
    s_lshl_b32 s50, s41, 5
    v_mfma_f32_32x32x16_bf16 v[48:63], v[132:135], v[96:99], 0
    v_add_u32 v24, s50, v24
    v_lshrrev_b32 v25, 5, v1
    s_waitcnt vmcnt(7)
L_ob1:
    v_cmp_eq_u32 vcc, -1, v100
    s_cbranch_vccnz L_obre1
L_obok1:
    v_mfma_f32_32x32x16_bf16 v[32:47], v[136:139], v[100:103], v[32:47]
    v_and_b32 v26, 15, v24
    v_xor_b32 v25, v25, v26
    v_mfma_f32_32x32x16_bf16 v[48:63], v[140:143], v[100:103], v[48:63]
    v_lshlrev_b32 v25, 4, v25
    v_lshl_add_u32 v25, v24, 8, v25
    s_waitcnt vmcnt(6)
L_ob2:
    v_cmp_eq_u32 vcc, -1, v104
    s_cbranch_vccnz L_obre2
L_obok2:
    v_mfma_f32_32x32x16_bf16 v[32:47], v[144:147], v[104:107], v[32:47]
    s_lshl_b32 s50, s42, 14
    v_add_u32 v25, s50, v25
    v_mfma_f32_32x32x16_bf16 v[48:63], v[148:151], v[104:107], v[48:63]
    v_xor_b32 v16, 0, v25
    v_xor_b32 v17, 32, v25
    s_waitcnt vmcnt(5)
L_ob3:
    v_cmp_eq_u32 vcc, -1, v108
    s_cbranch_vccnz L_obre3
L_obok3:
    v_mfma_f32_32x32x16_bf16 v[32:47], v[152:155], v[108:111], v[32:47]
    v_xor_b32 v18, 64, v25
    v_xor_b32 v19, 96, v25
    v_mfma_f32_32x32x16_bf16 v[48:63], v[156:159], v[108:111], v[48:63]
    v_xor_b32 v20, 128, v25
    v_xor_b32 v21, 160, v25
    s_waitcnt vmcnt(4)
L_ob4:
    v_cmp_eq_u32 vcc, -1, v112
    s_cbranch_vccnz L_obre4
L_obok4:
    v_mfma_f32_32x32x16_bf16 v[32:47], v[160:163], v[112:115], v[32:47]
    v_xor_b32 v22, 192, v25
    v_xor_b32 v23, 224, v25
    v_mfma_f32_32x32x16_bf16 v[48:63], v[164:167], v[112:115], v[48:63]
    v_lshrrev_b32 v24, 3, v1
    s_lshl_b32 s50, s40, 3
    s_waitcnt vmcnt(3)
L_ob5:
    v_cmp_eq_u32 vcc, -1, v116
    s_cbranch_vccnz L_obre5
L_obok5:
    v_mfma_f32_32x32x16_bf16 v[32:47], v[168:171], v[116:119], v[32:47]
    v_add_u32 v24, s50, v24
    v_and_b32 v26, 7, v1
    v_mfma_f32_32x32x16_bf16 v[48:63], v[172:175], v[116:119], v[48:63]
    v_lshlrev_b32 v26, 1, v26
    v_and_b32 v27, 15, v24
    s_waitcnt vmcnt(9)
    s_barrier
    s_waitcnt vmcnt(2)
L_ob6:
    v_cmp_eq_u32 vcc, -1, v120
    s_cbranch_vccnz L_obre6
L_obok6:
    v_mfma_f32_32x32x16_bf16 v[32:47], v[176:179], v[120:123], v[32:47]
    v_xor_b32 v26, v26, v27
    v_lshlrev_b32 v26, 4, v26
    v_mfma_f32_32x32x16_bf16 v[48:63], v[180:183], v[120:123], v[48:63]
    v_lshl_add_u32 v26, v24, 8, v26
    v_xor_b32 v27, 16, v26
    s_waitcnt lgkmcnt(8)
    ds_read_b64_tr_b16 v[192:193], v12 offset:0
    ds_read_b64_tr_b16 v[194:195], v12 offset:256
    ds_read_b64_tr_b16 v[196:197], v13 offset:0
    ds_read_b64_tr_b16 v[198:199], v13 offset:256
    s_waitcnt vmcnt(1)
L_ob7:
    v_cmp_eq_u32 vcc, -1, v124
    s_cbranch_vccnz L_obre7
L_obok7:
    v_mfma_f32_32x32x16_bf16 v[32:47], v[184:187], v[124:127], v[32:47]
    v_and_b32 v28, 7, v1
    v_lshlrev_b32 v28, 4, v28
    v_mfma_f32_32x32x16_bf16 v[48:63], v[188:191], v[124:127], v[48:63]
    v_lshl_add_u32 v28, v24, 10, v28
    s_waitcnt lgkmcnt(8)
    ds_read_b64_tr_b16 v[200:201], v12 offset:2048
    ds_read_b64_tr_b16 v[202:203], v12 offset:2304
    ds_read_b64_tr_b16 v[204:205], v13 offset:2048
    ds_read_b64_tr_b16 v[206:207], v13 offset:2304
    s_waitcnt vmcnt(0)
    buffer_load_dwordx4 v[64:67], v2, s[16:19], s74 offen offset:0 sc1
    buffer_load_dwordx4 v[68:71], v2, s[16:19], s74 offen offset:1024 sc1
    buffer_load_dwordx4 v[72:75], v2, s[16:19], s74 offen offset:2048 sc1
    buffer_load_dwordx4 v[76:79], v2, s[16:19], s74 offen offset:3072 sc1
    buffer_load_dwordx4 v[80:83], v2, s[16:19], s75 offen offset:0 sc1
    buffer_load_dwordx4 v[84:87], v2, s[16:19], s75 offen offset:1024 sc1
    buffer_load_dwordx4 v[88:91], v2, s[16:19], s75 offen offset:2048 sc1
    buffer_load_dwordx4 v[92:95], v2, s[16:19], s75 offen offset:3072 sc1
    s_waitcnt lgkmcnt(4)
    ds_read_b64_tr_b16 v[208:209], v12 offset:4096
    ds_read_b64_tr_b16 v[210:211], v12 offset:4352
    ds_read_b64_tr_b16 v[212:213], v13 offset:4096
    ds_read_b64_tr_b16 v[214:215], v13 offset:4352
    ds_read_b64_tr_b16 v[216:217], v12 offset:6144
    ds_read_b64_tr_b16 v[218:219], v12 offset:6400
    ds_read_b64_tr_b16 v[220:221], v13 offset:6144
    ds_read_b64_tr_b16 v[222:223], v13 offset:6400
    s_waitcnt lgkmcnt(4)
    ds_read_b64_tr_b16 v[224:225], v12 offset:8192
    ds_read_b64_tr_b16 v[226:227], v12 offset:8448
    ds_read_b64_tr_b16 v[228:229], v13 offset:8192
    ds_read_b64_tr_b16 v[230:231], v13 offset:8448
    ds_read_b64_tr_b16 v[232:233], v12 offset:10240
    ds_read_b64_tr_b16 v[234:235], v12 offset:10496
    ds_read_b64_tr_b16 v[236:237], v13 offset:10240
    ds_read_b64_tr_b16 v[238:239], v13 offset:10496
    s_waitcnt lgkmcnt(4)
    ds_read_b64_tr_b16 v[240:241], v12 offset:12288
    ds_read_b64_tr_b16 v[242:243], v12 offset:12544
    ds_read_b64_tr_b16 v[244:245], v13 offset:12288
    ds_read_b64_tr_b16 v[246:247], v13 offset:12544
    ds_read_b64_tr_b16 v[248:249], v12 offset:14336
    ds_read_b64_tr_b16 v[250:251], v12 offset:14592
    ds_read_b64_tr_b16 v[252:253], v13 offset:14336
    ds_read_b64_tr_b16 v[254:255], v13 offset:14592
    s_waitcnt vmcnt(7) lgkmcnt(8)
L_ob8:
    v_cmp_eq_u32 vcc, -1, v64
    s_cbranch_vccnz L_obre8
L_obok8:
    v_mfma_f32_32x32x16_bf16 v[32:47], v[192:195], v[64:67], v[32:47]
    v_mfma_f32_32x32x16_bf16 v[48:63], v[196:199], v[64:67], v[48:63]
    s_waitcnt vmcnt(6) lgkmcnt(8)
L_ob9:
    v_cmp_eq_u32 vcc, -1, v68
    s_cbranch_vccnz L_obre9
L_obok9:
    v_mfma_f32_32x32x16_bf16 v[32:47], v[200:203], v[68:71], v[32:47]
    v_mfma_f32_32x32x16_bf16 v[48:63], v[204:207], v[68:71], v[48:63]
    s_waitcnt vmcnt(5) lgkmcnt(8)
L_ob10:
    v_cmp_eq_u32 vcc, -1, v72
    s_cbranch_vccnz L_obre10
L_obok10:
    v_mfma_f32_32x32x16_bf16 v[32:47], v[208:211], v[72:75], v[32:47]
    v_mfma_f32_32x32x16_bf16 v[48:63], v[212:215], v[72:75], v[48:63]
    s_waitcnt vmcnt(4) lgkmcnt(8)
L_ob11:
    v_cmp_eq_u32 vcc, -1, v76
    s_cbranch_vccnz L_obre11
L_obok11:
    v_mfma_f32_32x32x16_bf16 v[32:47], v[216:219], v[76:79], v[32:47]
    v_mfma_f32_32x32x16_bf16 v[48:63], v[220:223], v[76:79], v[48:63]
    s_waitcnt vmcnt(3) lgkmcnt(8)
L_ob12:
    v_cmp_eq_u32 vcc, -1, v80
    s_cbranch_vccnz L_obre12
L_obok12:
    v_mfma_f32_32x32x16_bf16 v[32:47], v[224:227], v[80:83], v[32:47]
    v_mfma_f32_32x32x16_bf16 v[48:63], v[228:231], v[80:83], v[48:63]
    s_waitcnt vmcnt(2) lgkmcnt(8)
L_ob13:
    v_cmp_eq_u32 vcc, -1, v84
    s_cbranch_vccnz L_obre13
L_obok13:
    v_mfma_f32_32x32x16_bf16 v[32:47], v[232:235], v[84:87], v[32:47]
    v_mfma_f32_32x32x16_bf16 v[48:63], v[236:239], v[84:87], v[48:63]
    s_waitcnt vmcnt(1) lgkmcnt(4)
L_ob14:
    v_cmp_eq_u32 vcc, -1, v88
    s_cbranch_vccnz L_obre14
L_obok14:
    v_mfma_f32_32x32x16_bf16 v[32:47], v[240:243], v[88:91], v[32:47]
    v_mfma_f32_32x32x16_bf16 v[48:63], v[244:247], v[88:91], v[48:63]
    s_waitcnt vmcnt(0) lgkmcnt(0)
L_ob15:
    v_cmp_eq_u32 vcc, -1, v92
    s_cbranch_vccnz L_obre15
L_obok15:
    v_mfma_f32_32x32x16_bf16 v[32:47], v[248:251], v[92:95], v[32:47]
    v_mfma_f32_32x32x16_bf16 v[48:63], v[252:255], v[92:95], v[48:63]
    s_nop 10
    ds_write_b128 v16, v[32:35]
    ds_write_b128 v17, v[36:39]
    ds_write_b128 v18, v[40:43]
    ds_write_b128 v19, v[44:47]
    ds_write_b128 v20, v[48:51]
    ds_write_b128 v21, v[52:55]
    ds_write_b128 v22, v[56:59]
    ds_write_b128 v23, v[60:63]
    s_waitcnt lgkmcnt(0)
    s_barrier
    ds_read_b128 v[128:131], v26 offset:0
    ds_read_b128 v[132:135], v27 offset:0
    ds_read_b128 v[136:139], v26 offset:16384
    ds_read_b128 v[140:143], v27 offset:16384
    ds_read_b128 v[144:147], v26 offset:32768
    ds_read_b128 v[148:151], v27 offset:32768
    ds_read_b128 v[152:155], v26 offset:49152
    ds_read_b128 v[156:159], v27 offset:49152
    s_waitcnt lgkmcnt(4)
    v_pk_add_f32 v[128:129], v[128:129], v[136:137]
    v_pk_add_f32 v[130:131], v[130:131], v[138:139]
    v_pk_add_f32 v[132:133], v[132:133], v[140:141]
    v_pk_add_f32 v[134:135], v[134:135], v[142:143]
    s_waitcnt lgkmcnt(2)
    v_pk_add_f32 v[128:129], v[128:129], v[144:145]
    v_pk_add_f32 v[130:131], v[130:131], v[146:147]
    v_pk_add_f32 v[132:133], v[132:133], v[148:149]
    v_pk_add_f32 v[134:135], v[134:135], v[150:151]
    s_waitcnt lgkmcnt(0)
    v_pk_add_f32 v[128:129], v[128:129], v[152:153]
    v_pk_add_f32 v[130:131], v[130:131], v[154:155]
    v_pk_add_f32 v[132:133], v[132:133], v[156:157]
    v_pk_add_f32 v[134:135], v[134:135], v[158:159]
    v_cvt_pk_bf16_f32 v160, v128, v129
    v_cvt_pk_bf16_f32 v161, v130, v131
    v_cvt_pk_bf16_f32 v162, v132, v133
    v_cvt_pk_bf16_f32 v163, v134, v135
    buffer_store_dwordx4 v[160:163], v28, s[28:31], s89 offen
    s_or_b32 s51, s2, s40
    s_cmp_eq_u32 s51, 0
    s_cbranch_scc0 Lskip_29
    v_mov_b32 v24, s46
    v_lshlrev_b32 v25, 2, v1
    s_mov_b32 exec_lo, 0xffff
    s_mov_b32 exec_hi, 0x0
    buffer_store_dword v24, v25, s[16:19], 0 offen sc1
    s_mov_b64 exec, -1
Lskip_29:
L_exit:
    s_endpgm
L_obre0:
    s_mov_b32 s52, 0
    s_branch L_scan0
L_obre1:
    s_mov_b32 s52, 1
    s_branch L_scan0
L_obre2:
    s_mov_b32 s52, 2
    s_branch L_scan0
L_obre3:
    s_mov_b32 s52, 3
    s_branch L_scan0
L_obre4:
    s_mov_b32 s52, 4
    s_branch L_scan0
L_obre5:
    s_mov_b32 s52, 5
    s_branch L_scan0
L_obre6:
    s_mov_b32 s52, 6
    s_branch L_scan0
L_obre7:
    s_mov_b32 s52, 7
    s_branch L_scan0
L_scan0:
    s_waitcnt vmcnt(1)
    v_cmp_eq_u32 vcc, -1, v96
    s_cbranch_vccz L_sc0
    buffer_load_dwordx4 v[96:99], v2, s[16:19], s72 offen offset:0 sc1
L_sc0:
    v_cmp_eq_u32 vcc, -1, v100
    s_cbranch_vccz L_sc1
    buffer_load_dwordx4 v[100:103], v2, s[16:19], s72 offen offset:1024 sc1
L_sc1:
    v_cmp_eq_u32 vcc, -1, v104
    s_cbranch_vccz L_sc2
    buffer_load_dwordx4 v[104:107], v2, s[16:19], s72 offen offset:2048 sc1
L_sc2:
    v_cmp_eq_u32 vcc, -1, v108
    s_cbranch_vccz L_sc3
    buffer_load_dwordx4 v[108:111], v2, s[16:19], s72 offen offset:3072 sc1
L_sc3:
    v_cmp_eq_u32 vcc, -1, v112
    s_cbranch_vccz L_sc4
    buffer_load_dwordx4 v[112:115], v2, s[16:19], s73 offen offset:0 sc1
L_sc4:
    v_cmp_eq_u32 vcc, -1, v116
    s_cbranch_vccz L_sc5
    buffer_load_dwordx4 v[116:119], v2, s[16:19], s73 offen offset:1024 sc1
L_sc5:
    v_cmp_eq_u32 vcc, -1, v120
    s_cbranch_vccz L_sc6
    buffer_load_dwordx4 v[120:123], v2, s[16:19], s73 offen offset:2048 sc1
L_sc6:
    v_cmp_eq_u32 vcc, -1, v124
    s_cbranch_vccz L_sc7
    buffer_load_dwordx4 v[124:127], v2, s[16:19], s73 offen offset:3072 sc1
L_sc7:
    s_add_u32 s53, s53, 1
    s_cmp_gt_u32 s53, 200000
    s_waitcnt vmcnt(0)
    s_cbranch_scc1 L_give0
    s_cmp_eq_u32 s52, 0
    s_cbranch_scc1 L_ob0
    s_cmp_eq_u32 s52, 1
    s_cbranch_scc1 L_ob1
    s_cmp_eq_u32 s52, 2
    s_cbranch_scc1 L_ob2
    s_cmp_eq_u32 s52, 3
    s_cbranch_scc1 L_ob3
    s_cmp_eq_u32 s52, 4
    s_cbranch_scc1 L_ob4
    s_cmp_eq_u32 s52, 5
    s_cbranch_scc1 L_ob5
    s_cmp_eq_u32 s52, 6
    s_cbranch_scc1 L_ob6
    s_branch L_ob7
L_give0:
    s_cmp_eq_u32 s52, 0
    s_cbranch_scc1 L_obok0
    s_cmp_eq_u32 s52, 1
    s_cbranch_scc1 L_obok1
    s_cmp_eq_u32 s52, 2
    s_cbranch_scc1 L_obok2
    s_cmp_eq_u32 s52, 3
    s_cbranch_scc1 L_obok3
    s_cmp_eq_u32 s52, 4
    s_cbranch_scc1 L_obok4
    s_cmp_eq_u32 s52, 5
    s_cbranch_scc1 L_obok5
    s_cmp_eq_u32 s52, 6
    s_cbranch_scc1 L_obok6
    s_branch L_obok7
L_obre8:
    s_mov_b32 s52, 8
    s_branch L_scan1
L_obre9:
    s_mov_b32 s52, 9
    s_branch L_scan1
L_obre10:
    s_mov_b32 s52, 10
    s_branch L_scan1
L_obre11:
    s_mov_b32 s52, 11
    s_branch L_scan1
L_obre12:
    s_mov_b32 s52, 12
    s_branch L_scan1
L_obre13:
    s_mov_b32 s52, 13
    s_branch L_scan1
L_obre14:
    s_mov_b32 s52, 14
    s_branch L_scan1
L_obre15:
    s_mov_b32 s52, 15
    s_branch L_scan1
L_scan1:
    s_waitcnt vmcnt(0)
    v_cmp_eq_u32 vcc, -1, v64
    s_cbranch_vccz L_sc8
    buffer_load_dwordx4 v[64:67], v2, s[16:19], s74 offen offset:0 sc1
L_sc8:
    v_cmp_eq_u32 vcc, -1, v68
    s_cbranch_vccz L_sc9
    buffer_load_dwordx4 v[68:71], v2, s[16:19], s74 offen offset:1024 sc1
L_sc9:
    v_cmp_eq_u32 vcc, -1, v72
    s_cbranch_vccz L_sc10
    buffer_load_dwordx4 v[72:75], v2, s[16:19], s74 offen offset:2048 sc1
L_sc10:
    v_cmp_eq_u32 vcc, -1, v76
    s_cbranch_vccz L_sc11
    buffer_load_dwordx4 v[76:79], v2, s[16:19], s74 offen offset:3072 sc1
L_sc11:
    v_cmp_eq_u32 vcc, -1, v80
    s_cbranch_vccz L_sc12
    buffer_load_dwordx4 v[80:83], v2, s[16:19], s75 offen offset:0 sc1
L_sc12:
    v_cmp_eq_u32 vcc, -1, v84
    s_cbranch_vccz L_sc13
    buffer_load_dwordx4 v[84:87], v2, s[16:19], s75 offen offset:1024 sc1
L_sc13:
    v_cmp_eq_u32 vcc, -1, v88
    s_cbranch_vccz L_sc14
    buffer_load_dwordx4 v[88:91], v2, s[16:19], s75 offen offset:2048 sc1
L_sc14:
    v_cmp_eq_u32 vcc, -1, v92
    s_cbranch_vccz L_sc15
    buffer_load_dwordx4 v[92:95], v2, s[16:19], s75 offen offset:3072 sc1
L_sc15:
    s_add_u32 s53, s53, 1
    s_cmp_gt_u32 s53, 200000
    s_waitcnt vmcnt(0)
    s_cbranch_scc1 L_give1
    s_cmp_eq_u32 s52, 8
    s_cbranch_scc1 L_ob8
    s_cmp_eq_u32 s52, 9
    s_cbranch_scc1 L_ob9
    s_cmp_eq_u32 s52, 10
    s_cbranch_scc1 L_ob10
    s_cmp_eq_u32 s52, 11
    s_cbranch_scc1 L_ob11
    s_cmp_eq_u32 s52, 12
    s_cbranch_scc1 L_ob12
    s_cmp_eq_u32 s52, 13
    s_cbranch_scc1 L_ob13
    s_cmp_eq_u32 s52, 14
    s_cbranch_scc1 L_ob14
    s_branch L_ob15
L_give1:
    s_cmp_eq_u32 s52, 8
    s_cbranch_scc1 L_obok8
    s_cmp_eq_u32 s52, 9
    s_cbranch_scc1 L_obok9
    s_cmp_eq_u32 s52, 10
    s_cbranch_scc1 L_obok10
    s_cmp_eq_u32 s52, 11
    s_cbranch_scc1 L_obok11
    s_cmp_eq_u32 s52, 12
    s_cbranch_scc1 L_obok12
    s_cmp_eq_u32 s52, 13
    s_cbranch_scc1 L_obok13
    s_cmp_eq_u32 s52, 14
    s_cbranch_scc1 L_obok14
    s_branch L_obok15
L_roleB:
    s_waitcnt vmcnt(6) lgkmcnt(0)
    s_barrier
    v_mfma_f32_16x16x32_bf16 v[96:99], v[64:67], v[128:131], 0
    s_add_u32 m0, s63, 2048
    ds_read_b64_tr_b16 v[80:81], v124 offset:18432
    ds_read_b64_tr_b16 v[82:83], v124 offset:18944
    ds_read_b64_tr_b16 v[84:85], v124 offset:19456
    ds_read_b64_tr_b16 v[86:87], v124 offset:19968
    v_cndmask_b32 v121, v121, v122, s[58:59]
    ds_write_b32 v31, v121
    v_lshrrev_b32 v30, 5, v1
    v_mfma_f32_16x16x32_bf16 v[100:103], v[64:67], v[132:135], 0
    v_lshlrev_b32 v126, 6, v30
    v_xor_b32 v25, v126, v2
    v_xor_b32 v26, v126, v29
    s_add_u32 s0, s61, 16384
    v_cvt_pk_bf16_f32 v112, v48, v49
    v_cvt_pk_bf16_f32 v113, v50, v51
    v_cvt_pk_bf16_f32 v114, v52, v53
    v_cvt_pk_bf16_f32 v115, v54, v55
    v_mfma_f32_16x16x32_bf16 v[104:107], v[68:71], v[128:131], 0
    v_cvt_pk_bf16_f32 v116, v56, v57
    v_cvt_pk_bf16_f32 v117, v58, v59
    v_cvt_pk_bf16_f32 v118, v60, v61
    v_cvt_pk_bf16_f32 v119, v62, v63
    v_permlane16_swap_b32 v112, v114
    v_permlane16_swap_b32 v113, v115
    buffer_store_dwordx4 v[112:115], v2, s[16:19], s0 offen sc1
    v_permlane16_swap_b32 v116, v118
    v_mfma_f32_16x16x32_bf16 v[108:111], v[68:71], v[132:135], 0
    v_permlane16_swap_b32 v117, v119
    buffer_store_dwordx4 v[116:119], v25, s[16:19], s0 offen offset:1024 sc1
    v_cvt_pk_bf16_f32 v32, v32, v33
    v_cvt_pk_bf16_f32 v33, v34, v35
    v_cvt_pk_bf16_f32 v34, v36, v37
    v_cvt_pk_bf16_f32 v35, v38, v39
    v_cvt_pk_bf16_f32 v36, v40, v41
    v_cvt_pk_bf16_f32 v37, v42, v43
    v_mfma_f32_16x16x32_bf16 v[96:99], v[72:75], v[136:139], v[96:99]
    v_cvt_pk_bf16_f32 v38, v44, v45
    v_cvt_pk_bf16_f32 v39, v46, v47
    v_permlane16_swap_b32 v32, v34
    v_permlane16_swap_b32 v33, v35
    v_permlane16_swap_b32 v36, v38
    v_permlane16_swap_b32 v37, v39
    buffer_store_dwordx4 v[32:35], v2, s[16:19], s61 offen sc1
    buffer_store_dwordx4 v[36:39], v25, s[16:19], s61 offen offset:1024 sc1
    v_mfma_f32_16x16x32_bf16 v[100:103], v[72:75], v[140:143], v[100:103]
    ds_read_b64_tr_b16 v[88:89], v124 offset:26624
    ds_read_b64_tr_b16 v[90:91], v124 offset:27136
    ds_read_b64_tr_b16 v[92:93], v124 offset:27648
    ds_read_b64_tr_b16 v[94:95], v124 offset:28160
    buffer_load_dwordx4 v4, s[8:11], s37 offen offset:0 lds
    buffer_load_dwordx4 v4, s[12:15], s37 offen offset:1024 lds
    s_add_u32 m0, s63, 34816
    s_nop 0
    buffer_load_dwordx4 v4, s[8:11], s38 offen offset:0 lds
    buffer_load_dwordx4 v4, s[12:15], s38 offen offset:1024 lds
    v_mfma_f32_16x16x32_bf16 v[104:107], v[76:79], v[136:139], v[104:107]
    v_mfma_f32_16x16x32_bf16 v[108:111], v[76:79], v[140:143], v[108:111]
    s_waitcnt vmcnt(12) lgkmcnt(0)
    s_barrier
    v_mfma_f32_16x16x32_bf16 v[96:99], v[80:83], v[144:147], v[96:99]
    s_add_u32 m0, s63, 51200
    ds_read_b64_tr_b16 v[64:65], v6 offset:0
    ds_read_b64_tr_b16 v[66:67], v6 offset:512
    ds_read_b64_tr_b16 v[68:69], v6 offset:1024
    ds_read_b64_tr_b16 v[70:71], v6 offset:1536
    v_mfma_f32_16x16x32_bf16 v[100:103], v[80:83], v[148:151], v[100:103]
    buffer_load_dwordx4 v4, s[8:11], s39 offen offset:0 lds
    ds_write_b128 v29, v[32:35]
    ds_write_b128 v26, v[36:39] offset:1024
    ds_read2_b32 v[120:121], v28 offset0:0 offset1:64
    ds_read2_b32 v[122:123], v28 offset0:128 offset1:192
    v_mfma_f32_16x16x32_bf16 v[104:107], v[84:87], v[144:147], v[104:107]
    v_mov_b32 v28, s46
    s_add_u32 s0, s63, 133120
    v_add_u32 v126, s0, v2
    ds_read_b128 v[48:51], v126
    ds_read_b128 v[52:55], v126 offset:1024
    v_mul_u32_u24 v30, 5120, v30
    v_mfma_f32_16x16x32_bf16 v[108:111], v[84:87], v[148:151], v[108:111]
    v_and_b32 v127, 31, v1
    v_min_u32 v127, 16, v127
    v_lshl_add_u32 v30, v127, 4, v30
    s_add_u32 s0, s47, 155648
    v_add_u32 v27, s0, v2
    v_mfma_f32_16x16x32_bf16 v[96:99], v[88:91], v[152:155], v[96:99]
    s_lshl_b32 s60, s43, 5
    s_add_u32 s60, s60, s44
    s_mul_i32 s60, s60, 5120
    s_mul_i32 s0, s40, 640
    s_add_u32 s60, s60, s0
    v_mfma_f32_16x16x32_bf16 v[100:103], v[88:91], v[156:159], v[100:103]
    s_add_u32 s60, s60, 1048576
    ds_read_b64_tr_b16 v[72:73], v6 offset:8192
    ds_read_b64_tr_b16 v[74:75], v6 offset:8704
    ds_read_b64_tr_b16 v[76:77], v6 offset:9216
    ds_read_b64_tr_b16 v[78:79], v6 offset:9728
    buffer_load_dwordx4 v4, s[12:15], s39 offen offset:1024 lds
    v_mfma_f32_16x16x32_bf16 v[104:107], v[92:95], v[152:155], v[104:107]
    v_mfma_f32_16x16x32_bf16 v[108:111], v[92:95], v[156:159], v[108:111]
    s_waitcnt vmcnt(12) lgkmcnt(0)
    s_barrier
    v_mfma_f32_16x16x32_bf16 v[96:99], v[64:67], v[160:163], v[96:99]
    v_and_b32 v4, 0x380, v2
    v_and_b32 v5, 0x70, v2
    v_lshl_or_b32 v4, v4, 4, v5
    v_mfma_f32_16x16x32_bf16 v[100:103], v[64:67], v[164:167], v[100:103]
    v_xor_b32 v5, 64, v4
    ds_read_b64_tr_b16 v[80:81], v6 offset:16384
    ds_read_b64_tr_b16 v[82:83], v6 offset:16896
    v_mfma_f32_16x16x32_bf16 v[104:107], v[68:71], v[160:163], v[104:107]
    ds_read_b64_tr_b16 v[84:85], v6 offset:17408
    ds_read_b64_tr_b16 v[86:87], v6 offset:17920
    v_add_f32 v120, v120, v121
    v_add_f32 v122, v122, v123
    v_mfma_f32_16x16x32_bf16 v[108:111], v[68:71], v[164:167], v[108:111]
    v_add_f32 v120, v120, v122
    v_mul_f32 v120, 0xbfb8aa3b, v120
    v_exp_f32 v120, v120
    v_mfma_f32_16x16x32_bf16 v[96:99], v[72:75], v[168:171], v[96:99]
    s_nop 0
    v_add_f32 v120, 1.0, v120
    v_rcp_f32 v0, v120
    v_mfma_f32_16x16x32_bf16 v[100:103], v[72:75], v[172:175], v[100:103]
    ds_read_b64_tr_b16 v[88:89], v6 offset:24576
    ds_read_b64_tr_b16 v[90:91], v6 offset:25088
    ds_read_b64_tr_b16 v[92:93], v6 offset:25600
    ds_read_b64_tr_b16 v[94:95], v6 offset:26112
    v_mfma_f32_16x16x32_bf16 v[104:107], v[76:79], v[168:171], v[104:107]
    v_mfma_f32_16x16x32_bf16 v[108:111], v[76:79], v[172:175], v[108:111]
    s_waitcnt vmcnt(6) lgkmcnt(0)
    s_barrier
    v_mfma_f32_16x16x32_bf16 v[96:99], v[80:83], v[176:179], v[96:99]
    s_cmp_eq_u32 s40, 1
    s_cbranch_scc0 Lskip_9
    v_mov_b32 v127, s46
    s_mov_b64 exec, 1
    buffer_store_dword v127, v2, s[16:19], s62 offen sc1
    s_mov_b64 exec, -1
Lskip_9:
    s_add_u32 m0, s63, 83968
    v_mfma_f32_16x16x32_bf16 v[100:103], v[80:83], v[180:183], v[100:103]
    ds_read_b64_tr_b16 v[64:65], v6 offset:32768
    ds_read_b64_tr_b16 v[66:67], v6 offset:33280
    v_mfma_f32_16x16x32_bf16 v[104:107], v[84:87], v[176:179], v[104:107]
    ds_read_b64_tr_b16 v[68:69], v6 offset:33792
    ds_read_b64_tr_b16 v[70:71], v6 offset:34304
    v_mfma_f32_16x16x32_bf16 v[108:111], v[84:87], v[180:183], v[108:111]
    buffer_store_dwordx4 v[8:11], v2, s[16:19], s56 offen sc1
    buffer_load_dwordx4 v4, s[20:23], s64 offen offset:0 lds
    v_mfma_f32_16x16x32_bf16 v[96:99], v[88:91], v[184:187], v[96:99]
    ds_read_b64_tr_b16 v[72:73], v6 offset:40960
    ds_read_b64_tr_b16 v[74:75], v6 offset:41472
    v_mfma_f32_16x16x32_bf16 v[100:103], v[88:91], v[188:191], v[100:103]
    ds_read_b64_tr_b16 v[76:77], v6 offset:41984
    ds_read_b64_tr_b16 v[78:79], v6 offset:42496
    buffer_load_dwordx4 v5, s[20:23], s64 offen offset:1024 lds
    v_mfma_f32_16x16x32_bf16 v[104:107], v[92:95], v[184:187], v[104:107]
    v_mfma_f32_16x16x32_bf16 v[108:111], v[92:95], v[188:191], v[108:111]
    s_waitcnt vmcnt(7) lgkmcnt(0)
    s_barrier
    v_mfma_f32_16x16x32_bf16 v[96:99], v[64:67], v[192:195], v[96:99]
    s_add_u32 m0, s63, 100352
    ds_read_b64_tr_b16 v[80:81], v124 offset:2048
    v_mfma_f32_16x16x32_bf16 v[100:103], v[64:67], v[196:199], v[100:103]
    ds_read_b64_tr_b16 v[82:83], v124 offset:2560
    ds_read_b64_tr_b16 v[84:85], v124 offset:3072
    v_mfma_f32_16x16x32_bf16 v[104:107], v[68:71], v[192:195], v[104:107]
    ds_read_b64_tr_b16 v[86:87], v124 offset:3584
    buffer_store_dwordx4 v[8:11], v2, s[16:19], s57 offen sc1
    v_mfma_f32_16x16x32_bf16 v[108:111], v[68:71], v[196:199], v[108:111]
    buffer_load_dwordx4 v4, s[20:23], s65 offen offset:0 lds
    ds_read_b64_tr_b16 v[88:89], v124 offset:10240
    v_mfma_f32_16x16x32_bf16 v[96:99], v[72:75], v[200:203], v[96:99]
    ds_read_b64_tr_b16 v[90:91], v124 offset:10752
    ds_read_b64_tr_b16 v[92:93], v124 offset:11264
    v_mfma_f32_16x16x32_bf16 v[100:103], v[72:75], v[204:207], v[100:103]
    ds_read_b64_tr_b16 v[94:95], v124 offset:11776
    buffer_load_dwordx4 v5, s[20:23], s65 offen offset:1024 lds
    v_mfma_f32_16x16x32_bf16 v[104:107], v[76:79], v[200:203], v[104:107]
    v_mfma_f32_16x16x32_bf16 v[108:111], v[76:79], v[204:207], v[108:111]
    s_waitcnt vmcnt(8) lgkmcnt(0)
    s_barrier
    v_mfma_f32_16x16x32_bf16 v[96:99], v[80:83], v[208:211], v[96:99]
    s_add_u32 m0, s63, 116736
    ds_read_b64_tr_b16 v[64:65], v124 offset:34816
    v_mfma_f32_16x16x32_bf16 v[100:103], v[80:83], v[212:215], v[100:103]
    ds_read_b64_tr_b16 v[66:67], v124 offset:35328
    ds_read_b64_tr_b16 v[68:69], v124 offset:35840
    v_mfma_f32_16x16x32_bf16 v[104:107], v[84:87], v[208:211], v[104:107]
    ds_read_b64_tr_b16 v[70:71], v124 offset:36352
    s_mov_b64 exec, 3
    buffer_load_dword v57, v24, s[16:19], s83 offen sc1
    s_mov_b64 exec, -1
    v_mfma_f32_16x16x32_bf16 v[108:111], v[84:87], v[212:215], v[108:111]
    buffer_load_dwordx4 v4, s[20:23], s66 offen offset:0 lds
    ds_read_b64_tr_b16 v[72:73], v124 offset:43008
    v_mfma_f32_16x16x32_bf16 v[96:99], v[88:91], v[216:219], v[96:99]
    ds_read_b64_tr_b16 v[74:75], v124 offset:43520
    ds_read_b64_tr_b16 v[76:77], v124 offset:44032
    v_mfma_f32_16x16x32_bf16 v[100:103], v[88:91], v[220:223], v[100:103]
    ds_read_b64_tr_b16 v[78:79], v124 offset:44544
    buffer_load_dwordx4 v5, s[20:23], s66 offen offset:1024 lds
    v_mfma_f32_16x16x32_bf16 v[104:107], v[92:95], v[216:219], v[104:107]
    v_mfma_f32_16x16x32_bf16 v[108:111], v[92:95], v[220:223], v[108:111]
    s_waitcnt vmcnt(9) lgkmcnt(0)
    s_barrier
    v_mfma_f32_16x16x32_bf16 v[96:99], v[64:67], v[224:227], v[96:99]
    s_mov_b64 exec, s[90:91]
    buffer_load_dword v31, v24, s[16:19], s85 offen sc1
    s_mov_b64 exec, -1
    s_add_u32 m0, s63, 133120
    v_mfma_f32_16x16x32_bf16 v[100:103], v[64:67], v[228:231], v[100:103]
    ds_read_b64_tr_b16 v[80:81], v124 offset:51200
    ds_read_b64_tr_b16 v[82:83], v124 offset:51712
    v_mfma_f32_16x16x32_bf16 v[104:107], v[68:71], v[224:227], v[104:107]
    ds_read_b64_tr_b16 v[84:85], v124 offset:52224
    ds_read_b64_tr_b16 v[86:87], v124 offset:52736
    v_mfma_f32_16x16x32_bf16 v[108:111], v[68:71], v[228:231], v[108:111]
    buffer_load_dwordx4 v4, s[20:23], s67 offen offset:0 lds
    ds_read_b64_tr_b16 v[88:89], v124 offset:59392
    v_mfma_f32_16x16x32_bf16 v[96:99], v[72:75], v[232:235], v[96:99]
    ds_read_b64_tr_b16 v[90:91], v124 offset:59904
    ds_read_b64_tr_b16 v[92:93], v124 offset:60416
    v_mfma_f32_16x16x32_bf16 v[100:103], v[72:75], v[236:239], v[100:103]
    ds_read_b64_tr_b16 v[94:95], v124 offset:60928
    buffer_load_dwordx4 v5, s[20:23], s67 offen offset:1024 lds
    v_mfma_f32_16x16x32_bf16 v[104:107], v[76:79], v[232:235], v[104:107]
    v_mfma_f32_16x16x32_bf16 v[108:111], v[76:79], v[236:239], v[108:111]
    s_waitcnt lgkmcnt(0)
    s_barrier
    v_mfma_f32_16x16x32_bf16 v[96:99], v[80:83], v[240:243], v[96:99]
    v_mfma_f32_16x16x32_bf16 v[100:103], v[80:83], v[244:247], v[100:103]
    s_mov_b64 exec, 3
    s_waitcnt vmcnt(5)
    v_cmp_ne_u32 vcc, v28, v57
    s_cbranch_vccnz Lpoll_10
Lpd_11:
    s_mov_b64 exec, -1
    v_mfma_f32_16x16x32_bf16 v[104:107], v[84:87], v[240:243], v[104:107]
    buffer_load_dwordx4 v[128:131], v30, s[16:19], s60 offen offset:0 sc1
    v_mfma_f32_16x16x32_bf16 v[108:111], v[84:87], v[244:247], v[108:111]
    v_mfma_f32_16x16x32_bf16 v[96:99], v[88:91], v[248:251], v[96:99]
    buffer_load_dwordx4 v[132:135], v30, s[16:19], s60 offen offset:320 sc1
    v_mfma_f32_16x16x32_bf16 v[100:103], v[88:91], v[252:255], v[100:103]
    s_mov_b64 exec, s[90:91]
    s_waitcnt vmcnt(4)
    v_cmp_ne_u32 vcc, v28, v31
    s_cbranch_vccnz Lpoll_12
Lpd_13:
    s_mov_b64 exec, -1
    v_mfma_f32_16x16x32_bf16 v[104:107], v[92:95], v[248:251], v[104:107]
    v_mfma_f32_16x16x32_bf16 v[108:111], v[92:95], v[252:255], v[108:111]
    v_mov_b32 v112, 0x3eb8aa3b
    s_nop 4
    v_cvt_pk_bf16_f32 v96, v96, v97
    v_cvt_pk_bf16_f32 v97, v98, v99
    v_cvt_pk_bf16_f32 v98, v100, v101
    v_cvt_pk_bf16_f32 v99, v102, v103
    v_mul_f32 v104, v104, v112
    v_mul_f32 v105, v105, v112
    v_permlane16_swap_b32 v96, v98
    v_permlane16_swap_b32 v97, v99
    v_mul_f32 v106, v106, v112
    v_mul_f32 v107, v107, v112
    v_mfma_f32_32x32x16_bf16 v[32:47], v[12:15], v[96:99], 0
    v_mul_f32 v108, v108, v112
    v_mul_f32 v109, v109, v112
    v_mul_f32 v110, v110, v112
    v_mul_f32 v111, v111, v112
    v_cvt_pk_bf16_f32 v8, v104, v105
    v_cvt_pk_bf16_f32 v9, v106, v107
    v_cvt_pk_bf16_f32 v10, v108, v109
    v_cvt_pk_bf16_f32 v11, v110, v111
    s_nop 0
    v_permlane16_swap_b32 v8, v10
    v_permlane16_swap_b32 v9, v11
    s_nop 0
    v_max3_f32 v113, v32, v33, v34
    v_max3_f32 v114, v35, v36, v37
    v_max3_f32 v115, v38, v39, v40
    v_max3_f32 v116, v41, v42, v43
    v_max3_f32 v117, v44, v45, v46
    s_add_u32 m0, s1, 32768
    v_add_u32 v3, s86, v2
    buffer_load_dwordx4 v3, s[4:7], 0 offen offset:0 sc1 lds
    v_mov_b32 v112, 0x3fb8aa3b
    v_max3_f32 v113, v113, v114, v47
    v_max3_f32 v115, v115, v116, v117
    v_max_f32 v113, v113, v115
    buffer_load_dwordx4 v3, s[4:7], 0 offen offset:1024 sc1 lds
    v_mul_f32 v114, v112, v113
    v_pk_fma_f32 v[32:33], v[32:33], v[112:113], v[114:115] op_sel_hi:[1,0,0] neg_lo:[0,0,1] neg_hi:[0,0,1]
    v_pk_fma_f32 v[34:35], v[34:35], v[112:113], v[114:115] op_sel_hi:[1,0,0] neg_lo:[0,0,1] neg_hi:[0,0,1]
    v_pk_fma_f32 v[36:37], v[36:37], v[112:113], v[114:115] op_sel_hi:[1,0,0] neg_lo:[0,0,1] neg_hi:[0,0,1]
    buffer_load_dwordx4 v3, s[4:7], 0 offen offset:2048 sc1 lds
    v_pk_fma_f32 v[38:39], v[38:39], v[112:113], v[114:115] op_sel_hi:[1,0,0] neg_lo:[0,0,1] neg_hi:[0,0,1]
    v_pk_fma_f32 v[40:41], v[40:41], v[112:113], v[114:115] op_sel_hi:[1,0,0] neg_lo:[0,0,1] neg_hi:[0,0,1]
    v_pk_fma_f32 v[42:43], v[42:43], v[112:113], v[114:115] op_sel_hi:[1,0,0] neg_lo:[0,0,1] neg_hi:[0,0,1]
    v_pk_fma_f32 v[44:45], v[44:45], v[112:113], v[114:115] op_sel_hi:[1,0,0] neg_lo:[0,0,1] neg_hi:[0,0,1]
    buffer_load_dwordx4 v3, s[4:7], 0 offen offset:3072 sc1 lds
    v_pk_fma_f32 v[46:47], v[46:47], v[112:113], v[114:115] op_sel_hi:[1,0,0] neg_lo:[0,0,1] neg_hi:[0,0,1]
    v_exp_f32 v32, v32
    v_exp_f32 v33, v33
    v_exp_f32 v34, v34
    v_exp_f32 v35, v35
    v_exp_f32 v36, v36
    v_pk_add_f32 v[112:113], v[32:33], v[34:35]
    v_exp_f32 v37, v37
    v_exp_f32 v38, v38
    v_pk_add_f32 v[112:113], v[112:113], v[36:37]
    v_exp_f32 v39, v39
    v_exp_f32 v40, v40
    v_pk_add_f32 v[112:113], v[112:113], v[38:39]
    v_exp_f32 v41, v41
    v_exp_f32 v42, v42
    v_pk_add_f32 v[112:113], v[112:113], v[40:41]
    v_exp_f32 v43, v43
    v_exp_f32 v44, v44
    v_pk_add_f32 v[112:113], v[112:113], v[42:43]
    v_exp_f32 v45, v45
    v_exp_f32 v46, v46
    v_pk_add_f32 v[112:113], v[112:113], v[44:45]
    v_exp_f32 v47, v47
    s_nop 0
    v_pk_add_f32 v[112:113], v[112:113], v[46:47]
    v_add_f32 v112, v112, v113
    v_rcp_f32 v112, v112
    s_nop 0
    v_pk_mul_f32 v[32:33], v[32:33], v[112:113] op_sel_hi:[1,0]
    v_pk_mul_f32 v[34:35], v[34:35], v[112:113] op_sel_hi:[1,0]
    v_pk_mul_f32 v[36:37], v[36:37], v[112:113] op_sel_hi:[1,0]
    v_pk_mul_f32 v[38:39], v[38:39], v[112:113] op_sel_hi:[1,0]
    v_pk_mul_f32 v[40:41], v[40:41], v[112:113] op_sel_hi:[1,0]
    v_pk_mul_f32 v[42:43], v[42:43], v[112:113] op_sel_hi:[1,0]
    v_pk_mul_f32 v[44:45], v[44:45], v[112:113] op_sel_hi:[1,0]
    v_pk_mul_f32 v[46:47], v[46:47], v[112:113] op_sel_hi:[1,0]
    v_cvt_pk_bf16_f32 v64, v32, v33
    v_cvt_pk_bf16_f32 v65, v34, v35
    v_cvt_pk_bf16_f32 v66, v36, v37
    v_cvt_pk_bf16_f32 v67, v38, v39
    v_cvt_pk_bf16_f32 v68, v40, v41
    v_cvt_pk_bf16_f32 v69, v42, v43
    v_cvt_pk_bf16_f32 v70, v44, v45
    v_cvt_pk_bf16_f32 v71, v46, v47
    s_waitcnt vmcnt(4)
    v_max_u32 v57, v128, v132
    v_cmp_eq_u32 vcc, -1, v57
    s_cbranch_vccnz L_h1re
L_h1ok:
    v_add_f32 v128, v128, v132
    v_add_f32 v129, v129, v133
    v_add_f32 v130, v130, v134
    v_add_f32 v131, v131, v135
    ds_write_b128 v27, v[128:131]
    s_waitcnt vmcnt(6) lgkmcnt(0)
    s_barrier
    s_cmp_eq_u32 s40, 1
    s_cbranch_scc0 Lskip_14
    v_mov_b32 v127, s46
    s_mov_b64 exec, 1
    buffer_store_dword v127, v2, s[16:19], s49 offen sc1
    s_mov_b64 exec, -1
Lskip_14:
    s_cmp_eq_u32 s40, 0
    s_cbranch_scc0 Lskip_15
    ds_read_b128 v[208:211], v27 offset:0
    ds_read_b128 v[212:215], v27 offset:1024
    ds_read_b128 v[216:219], v27 offset:2048
    ds_read_b128 v[220:223], v27 offset:3072
    ds_read_b128 v[224:227], v27 offset:4096
    ds_read_b128 v[228:231], v27 offset:5120
    ds_read_b128 v[232:235], v27 offset:6144
    ds_read_b128 v[236:239], v27 offset:7168
    v_lshlrev_b32 v57, 3, v1
    s_waitcnt lgkmcnt(0)
    v_pk_add_f32 v[208:209], v[208:209], v[224:225]
    v_pk_add_f32 v[210:211], v[210:211], v[226:227]
    v_pk_add_f32 v[212:213], v[212:213], v[228:229]
    v_pk_add_f32 v[214:215], v[214:215], v[230:231]
    v_pk_add_f32 v[216:217], v[216:217], v[232:233]
    v_pk_add_f32 v[218:219], v[218:219], v[234:235]
    v_pk_add_f32 v[220:221], v[220:221], v[236:237]
    v_pk_add_f32 v[222:223], v[222:223], v[238:239]
    v_pk_add_f32 v[208:209], v[208:209], v[216:217]
    v_pk_add_f32 v[210:211], v[210:211], v[218:219]
    v_pk_add_f32 v[212:213], v[212:213], v[220:221]
    v_pk_add_f32 v[214:215], v[214:215], v[222:223]
    v_pk_add_f32 v[208:209], v[208:209], v[212:213]
    v_pk_add_f32 v[210:211], v[210:211], v[214:215]
    v_cvt_pk_bf16_f32 v218, v208, v209
    v_cvt_pk_bf16_f32 v219, v210, v211
    s_mov_b32 exec_lo, 0xffffff
    s_mov_b32 exec_hi, 0xffffff
    buffer_store_dwordx2 v[218:219], v57, s[16:19], s3 offen sc1
    s_mov_b64 exec, -1
Lskip_15:
    s_branch L_merge
Lpoll_10:
    s_mov_b32 s53, 0
Lpoll_10b:
    buffer_load_dword v57, v24, s[16:19], s83 offen sc1
    s_add_u32 s53, s53, 1
    s_cmp_gt_u32 s53, 200000
    s_waitcnt vmcnt(0)
    s_cbranch_scc1 Lpd_11
    v_cmp_ne_u32 vcc, v28, v57
    s_cbranch_vccnz Lpoll_10b
    s_branch Lpd_11
Lpoll_12:
    s_mov_b32 s53, 0
Lpoll_12b:
    buffer_load_dword v31, v24, s[16:19], s85 offen sc1
    s_add_u32 s53, s53, 1
    s_cmp_gt_u32 s53, 200000
    s_waitcnt vmcnt(0)
    s_cbranch_scc1 Lpd_13
    v_cmp_ne_u32 vcc, v28, v31
    s_cbranch_vccnz Lpoll_12b
    s_branch Lpd_13
L_h1re:
    s_mov_b32 s53, 0
L_h1reb:
    buffer_load_dwordx4 v[128:131], v30, s[16:19], s60 offen offset:0 sc1
    buffer_load_dwordx4 v[132:135], v30, s[16:19], s60 offen offset:320 sc1
    s_add_u32 s53, s53, 1
    s_cmp_gt_u32 s53, 200000
    s_waitcnt vmcnt(0)
    s_cbranch_scc1 L_h1ok
    v_max_u32 v57, v128, v132
    v_cmp_eq_u32 vcc, -1, v57
    s_cbranch_vccnz L_h1reb
    s_branch L_h1ok
Lpoll_17:
    s_mov_b32 s53, 0
Lpoll_17b:
    buffer_load_dword v31, v24, s[16:19], s85 offen sc1
    s_add_u32 s53, s53, 1
    s_cmp_gt_u32 s53, 200000
    s_waitcnt vmcnt(0)
    s_cbranch_scc1 Lpd_18
    v_cmp_ne_u32 vcc, v28, v31
    s_cbranch_vccnz Lpoll_17b
    s_branch Lpd_18
Lpoll_20:
    s_mov_b32 s53, 0
Lpoll_20b:
    buffer_load_dword v58, v24, s[16:19], s84 offen sc1
    s_add_u32 s53, s53, 1
    s_cmp_gt_u32 s53, 200000
    s_waitcnt vmcnt(0)
    s_cbranch_scc1 Lpd_21
    v_cmp_ne_u32 vcc, v28, v58
    s_cbranch_vccnz Lpoll_20b
    s_branch Lpd_21
Lkv_23:
    s_mov_b32 s53, 0
Lkv_23b:
    buffer_load_dwordx2 v[72:73], v52, s[16:19], s87 offen offset:0 sc1
    buffer_load_dwordx2 v[74:75], v52, s[16:19], s87 offen offset:256 sc1
    buffer_load_dwordx2 v[76:77], v52, s[16:19], s87 offen offset:512 sc1
    buffer_load_dwordx2 v[78:79], v52, s[16:19], s87 offen offset:768 sc1
    s_add_u32 s53, s53, 1
    s_cmp_gt_u32 s53, 200000
    s_waitcnt vmcnt(0)
    s_cbranch_scc1 Lkvd_24
    v_max3_u32 v120, v72, v74, v76
    v_max_u32 v120, v120, v78
    v_cmp_eq_u32 vcc, -1, v120
    s_cbranch_vccnz Lkv_23b
    s_branch Lkvd_24
Lpoll_26:
    s_mov_b32 s53, 0
Lpoll_26b:
    buffer_load_dword v56, v24, s[16:19], s88 offen sc1
    s_add_u32 s53, s53, 1
    s_cmp_gt_u32 s53, 200000
    s_waitcnt vmcnt(0)
    s_cbranch_scc1 Lpd_27
    v_cmp_ne_u32 vcc, v28, v56
    s_cbranch_vccnz Lpoll_26b
    s_branch Lpd_27
L_ex7:
    s_mov_b64 exec, 3
    buffer_load_dword v56, v24, s[16:19], s88 offen sc1
    s_mov_b64 exec, -1
    s_add_u32 m0, s63, 83968
    s_nop 0
L_ex6:
    buffer_load_dwordx4 v4, s[24:27], s64 offen offset:0 lds
    s_waitcnt vmcnt(2)
    v_max3_u32 v120, v72, v74, v76
    v_max_u32 v120, v120, v78
    v_cmp_eq_u32 vcc, -1, v120
    s_cbranch_vccnz Lkv_23x
Lkvd_24x:
    v_mfma_f32_32x32x16_bf16 v[96:111], v[72:75], v[64:67], 0
    v_mfma_f32_32x32x16_bf16 v[96:111], v[76:79], v[68:71], v[96:111]
    s_nop 11
    v_add_f32 v120, 0x358637bd, v104
    v_rcp_f32 v120, v120
    s_nop 0
    buffer_load_dwordx4 v5, s[24:27], s64 offen offset:1024 lds
    s_add_u32 m0, s63, 100352
    s_nop 0
    v_mul_f32 v120, v120, v0
    v_mul_f32 v96, v96, v120
    v_mul_f32 v97, v97, v120
    v_mul_f32 v98, v98, v120
    v_mul_f32 v99, v99, v120
    v_mul_f32 v100, v100, v120
    v_mul_f32 v101, v101, v120
    v_mul_f32 v102, v102, v120
    v_mul_f32 v103, v103, v120
    v_cvt_pk_bf16_f32 v112, v96, v97
    v_cvt_pk_bf16_f32 v113, v98, v99
    v_cvt_pk_bf16_f32 v114, v100, v101
    v_cvt_pk_bf16_f32 v115, v102, v103
    buffer_store_dwordx4 v[112:115], v2, s[16:19], s56 offen sc1
L_ex5:
    s_waitcnt vmcnt(8)
    s_barrier
    buffer_load_dwordx4 v4, s[24:27], s65 offen offset:0 lds
    buffer_load_dwordx4 v5, s[24:27], s65 offen offset:1024 lds
    s_add_u32 m0, s63, 116736
    s_nop 0
L_ex4:
    s_mov_b64 exec, 3
    s_waitcnt vmcnt(5)
    v_cmp_ne_u32 vcc, v28, v56
    s_cbranch_vccnz Lpoll_26x
Lpd_27x:
    s_mov_b64 exec, -1
    buffer_load_dwordx4 v4, s[24:27], s66 offen offset:0 lds
    buffer_load_dwordx4 v5, s[24:27], s66 offen offset:1024 lds
    s_add_u32 m0, s63, 133120
    s_nop 0
L_ex3:
    buffer_load_dwordx4 v4, s[24:27], s67 offen offset:0 lds
    buffer_load_dwordx4 v5, s[24:27], s67 offen offset:1024 lds
L_ex2:
    buffer_load_dwordx4 v[96:99], v2, s[16:19], s72 offen offset:0 sc1
    buffer_load_dwordx4 v[100:103], v2, s[16:19], s72 offen offset:1024 sc1
    buffer_load_dwordx4 v[104:107], v2, s[16:19], s72 offen offset:2048 sc1
    buffer_load_dwordx4 v[108:111], v2, s[16:19], s72 offen offset:3072 sc1
L_ex1:
    buffer_load_dwordx4 v[112:115], v2, s[16:19], s73 offen offset:0 sc1
    buffer_load_dwordx4 v[116:119], v2, s[16:19], s73 offen offset:1024 sc1
    buffer_load_dwordx4 v[120:123], v2, s[16:19], s73 offen offset:2048 sc1
    buffer_load_dwordx4 v[124:127], v2, s[16:19], s73 offen offset:3072 sc1
L_ex0:
    s_waitcnt lgkmcnt(0)
    s_setprio 0
    s_branch L_attn_end
Lkv_23x:
    s_mov_b32 s53, 0
Lkv_23xb:
    buffer_load_dwordx2 v[72:73], v52, s[16:19], s87 offen offset:0 sc1
    buffer_load_dwordx2 v[74:75], v52, s[16:19], s87 offen offset:256 sc1
    buffer_load_dwordx2 v[76:77], v52, s[16:19], s87 offen offset:512 sc1
    buffer_load_dwordx2 v[78:79], v52, s[16:19], s87 offen offset:768 sc1
    s_add_u32 s53, s53, 1
    s_cmp_gt_u32 s53, 200000
    s_waitcnt vmcnt(0)
    s_cbranch_scc1 Lkvd_24x
    v_max3_u32 v120, v72, v74, v76
    v_max_u32 v120, v120, v78
    v_cmp_eq_u32 vcc, -1, v120
    s_cbranch_vccnz Lkv_23xb
    s_branch Lkvd_24x
Lpoll_26x:
    s_mov_b32 s53, 0
Lpoll_26xb:
    buffer_load_dword v56, v24, s[16:19], s88 offen sc1
    s_add_u32 s53, s53, 1
    s_cmp_gt_u32 s53, 200000
    s_waitcnt vmcnt(0)
    s_cbranch_scc1 Lpd_27x
    v_cmp_ne_u32 vcc, v28, v56
    s_cbranch_vccnz Lpoll_26xb
    s_branch Lpd_27x
L_maxpath:
    v_mov_b32 v4, 0xff800000
    v_lshrrev_b32 v6, 5, v1
    v_lshlrev_b32 v6, 2, v6
    v_and_b32 v5, 31, v1
    v_sub_u32 v6, v5, v6
    v_mov_b32 v24, v4
    s_mov_b32 s50, 8
    s_min_u32 s51, s48, 8
    s_sub_u32 s51, 8, s51
    v_mov_b32 v5, v29
    v_lshl_add_u32 v49, v50, 3, v51
L_mx0:
    ds_read_b128 v[248:251], v5
    s_waitcnt lgkmcnt(0)
    v_mfma_f32_32x32x16_bf16 v[192:207], v[248:251], v[8:11], 0
    s_nop 15
    s_cmp_eq_u32 s50, 8
    s_cbranch_scc0 Lskip_30
    v_cmp_gt_i32 vcc, 0, v6
    s_nop 1
    v_cndmask_b32_e64 v192, v192, v4, vcc
    v_cmp_gt_i32 vcc, 1, v6
    s_nop 1
    v_cndmask_b32_e64 v193, v193, v4, vcc
    v_cmp_gt_i32 vcc, 2, v6
    s_nop 1
    v_cndmask_b32_e64 v194, v194, v4, vcc
    v_cmp_gt_i32 vcc, 3, v6
    s_nop 1
    v_cndmask_b32_e64 v195, v195, v4, vcc
    v_cmp_gt_i32 vcc, 8, v6
    s_nop 1
    v_cndmask_b32_e64 v196, v196, v4, vcc
    v_cmp_gt_i32 vcc, 9, v6
    s_nop 1
    v_cndmask_b32_e64 v197, v197, v4, vcc
    v_cmp_gt_i32 vcc, 10, v6
    s_nop 1
    v_cndmask_b32_e64 v198, v198, v4, vcc
    v_cmp_gt_i32 vcc, 11, v6
    s_nop 1
    v_cndmask_b32_e64 v199, v199, v4, vcc
    v_cmp_gt_i32 vcc, 16, v6
    s_nop 1
    v_cndmask_b32_e64 v200, v200, v4, vcc
    v_cmp_gt_i32 vcc, 17, v6
    s_nop 1
    v_cndmask_b32_e64 v201, v201, v4, vcc
    v_cmp_gt_i32 vcc, 18, v6
    s_nop 1
    v_cndmask_b32_e64 v202, v202, v4, vcc
    v_cmp_gt_i32 vcc, 19, v6
    s_nop 1
    v_cndmask_b32_e64 v203, v203, v4, vcc
    v_cmp_gt_i32 vcc, 24, v6
    s_nop 1
    v_cndmask_b32_e64 v204, v204, v4, vcc
    v_cmp_gt_i32 vcc, 25, v6
    s_nop 1
    v_cndmask_b32_e64 v205, v205, v4, vcc
    v_cmp_gt_i32 vcc, 26, v6
    s_nop 1
    v_cndmask_b32_e64 v206, v206, v4, vcc
    v_cmp_gt_i32 vcc, 27, v6
    s_nop 1
    v_cndmask_b32_e64 v207, v207, v4, vcc
Lskip_30:
    s_cmp_eq_u32 s50, 0
    s_cbranch_scc0 Lskip_31
    v_cmp_le_i32 vcc, 0, v6
    s_nop 1
    v_cndmask_b32_e64 v192, v192, v4, vcc
    v_cmp_le_i32 vcc, 1, v6
    s_nop 1
    v_cndmask_b32_e64 v193, v193, v4, vcc
    v_cmp_le_i32 vcc, 2, v6
    s_nop 1
    v_cndmask_b32_e64 v194, v194, v4, vcc
    v_cmp_le_i32 vcc, 3, v6
    s_nop 1
    v_cndmask_b32_e64 v195, v195, v4, vcc
    v_cmp_le_i32 vcc, 8, v6
    s_nop 1
    v_cndmask_b32_e64 v196, v196, v4, vcc
    v_cmp_le_i32 vcc, 9, v6
    s_nop 1
    v_cndmask_b32_e64 v197, v197, v4, vcc
    v_cmp_le_i32 vcc, 10, v6
    s_nop 1
    v_cndmask_b32_e64 v198, v198, v4, vcc
    v_cmp_le_i32 vcc, 11, v6
    s_nop 1
    v_cndmask_b32_e64 v199, v199, v4, vcc
    v_cmp_le_i32 vcc, 16, v6
    s_nop 1
    v_cndmask_b32_e64 v200, v200, v4, vcc
    v_cmp_le_i32 vcc, 17, v6
    s_nop 1
    v_cndmask_b32_e64 v201, v201, v4, vcc
    v_cmp_le_i32 vcc, 18, v6
    s_nop 1
    v_cndmask_b32_e64 v202, v202, v4, vcc
    v_cmp_le_i32 vcc, 19, v6
    s_nop 1
    v_cndmask_b32_e64 v203, v203, v4, vcc
    v_cmp_le_i32 vcc, 24, v6
    s_nop 1
    v_cndmask_b32_e64 v204, v204, v4, vcc
    v_cmp_le_i32 vcc, 25, v6
    s_nop 1
    v_cndmask_b32_e64 v205, v205, v4, vcc
    v_cmp_le_i32 vcc, 26, v6
    s_nop 1
    v_cndmask_b32_e64 v206, v206, v4, vcc
    v_cmp_le_i32 vcc, 27, v6
    s_nop 1
    v_cndmask_b32_e64 v207, v207, v4, vcc
Lskip_31:
    v_max3_f32 v24, v24, v192, v193
    v_max3_f32 v24, v24, v194, v195
    v_max3_f32 v24, v24, v196, v197
    v_max3_f32 v24, v24, v198, v199
    v_max3_f32 v24, v24, v200, v201
    v_max3_f32 v24, v24, v202, v203
    v_max3_f32 v24, v24, v204, v205
    v_max3_f32 v24, v24, v206, v207
    v_subrev_u32 v5, 8192, v5
    v_sub_u32 v49, v49, v50
    s_sub_u32 s50, s50, 1
    s_cmp_ge_i32 s50, s51
    s_cbranch_scc1 L_mx0
    v_mov_b32 v5, v24
    s_nop 1
    v_permlane32_swap_b32 v24, v5
    s_nop 1
    v_max_f32 v24, v24, v5
    v_sub_f32 v32, 0, v24
    v_sub_f32 v33, 0, v24
    v_sub_f32 v34, 0, v24
    v_sub_f32 v35, 0, v24
    v_sub_f32 v36, 0, v24
    v_sub_f32 v37, 0, v24
    v_sub_f32 v38, 0, v24
    v_sub_f32 v39, 0, v24
    v_sub_f32 v40, 0, v24
    v_sub_f32 v41, 0, v24
    v_sub_f32 v42, 0, v24
    v_sub_f32 v43, 0, v24
    v_sub_f32 v44, 0, v24
    v_sub_f32 v45, 0, v24
    v_sub_f32 v46, 0, v24
    v_sub_f32 v47, 0, v24
    v_mov_b32 v224, 0
    v_mov_b32 v225, 0
    v_mov_b32 v226, 0
    v_mov_b32 v227, 0
    v_mov_b32 v228, 0
    v_mov_b32 v229, 0
    v_mov_b32 v230, 0
    v_mov_b32 v231, 0
    v_mov_b32 v232, 0
    v_mov_b32 v233, 0
    v_mov_b32 v234, 0
    v_mov_b32 v235, 0
    v_mov_b32 v236, 0
    v_mov_b32 v237, 0
    v_mov_b32 v238, 0
    v_mov_b32 v239, 0
    s_mov_b32 s50, 8
    s_min_u32 s51, s48, 8
    s_sub_u32 s51, 8, s51
    v_mov_b32 v5, v29
    v_lshl_add_u32 v49, v50, 3, v51
L_mx1:
    ds_read_b128 v[248:251], v5
    ds_read_b64_tr_b16 v[80:81], v49 offset:0
    ds_read_b64_tr_b16 v[82:83], v49 offset:128
    ds_read_b64_tr_b16 v[84:85], v49 offset:256
    ds_read_b64_tr_b16 v[86:87], v49 offset:384
    s_waitcnt lgkmcnt(0)
    v_mfma_f32_32x32x16_bf16 v[192:207], v[248:251], v[8:11], v[32:47]
    s_nop 15
    s_cmp_eq_u32 s50, 8
    s_cbranch_scc0 Lskip_32
    v_cmp_gt_i32 vcc, 0, v6
    s_nop 1
    v_cndmask_b32_e64 v192, v192, v4, vcc
    v_cmp_gt_i32 vcc, 1, v6
    s_nop 1
    v_cndmask_b32_e64 v193, v193, v4, vcc
    v_cmp_gt_i32 vcc, 2, v6
    s_nop 1
    v_cndmask_b32_e64 v194, v194, v4, vcc
    v_cmp_gt_i32 vcc, 3, v6
    s_nop 1
    v_cndmask_b32_e64 v195, v195, v4, vcc
    v_cmp_gt_i32 vcc, 8, v6
    s_nop 1
    v_cndmask_b32_e64 v196, v196, v4, vcc
    v_cmp_gt_i32 vcc, 9, v6
    s_nop 1
    v_cndmask_b32_e64 v197, v197, v4, vcc
    v_cmp_gt_i32 vcc, 10, v6
    s_nop 1
    v_cndmask_b32_e64 v198, v198, v4, vcc
    v_cmp_gt_i32 vcc, 11, v6
    s_nop 1
    v_cndmask_b32_e64 v199, v199, v4, vcc
    v_cmp_gt_i32 vcc, 16, v6
    s_nop 1
    v_cndmask_b32_e64 v200, v200, v4, vcc
    v_cmp_gt_i32 vcc, 17, v6
    s_nop 1
    v_cndmask_b32_e64 v201, v201, v4, vcc
    v_cmp_gt_i32 vcc, 18, v6
    s_nop 1
    v_cndmask_b32_e64 v202, v202, v4, vcc
    v_cmp_gt_i32 vcc, 19, v6
    s_nop 1
    v_cndmask_b32_e64 v203, v203, v4, vcc
    v_cmp_gt_i32 vcc, 24, v6
    s_nop 1
    v_cndmask_b32_e64 v204, v204, v4, vcc
    v_cmp_gt_i32 vcc, 25, v6
    s_nop 1
    v_cndmask_b32_e64 v205, v205, v4, vcc
    v_cmp_gt_i32 vcc, 26, v6
    s_nop 1
    v_cndmask_b32_e64 v206, v206, v4, vcc
    v_cmp_gt_i32 vcc, 27, v6
    s_nop 1
    v_cndmask_b32_e64 v207, v207, v4, vcc
Lskip_32:
    s_cmp_eq_u32 s50, 0
    s_cbranch_scc0 Lskip_33
    v_cmp_le_i32 vcc, 0, v6
    s_nop 1
    v_cndmask_b32_e64 v192, v192, v4, vcc
    v_cmp_le_i32 vcc, 1, v6
    s_nop 1
    v_cndmask_b32_e64 v193, v193, v4, vcc
    v_cmp_le_i32 vcc, 2, v6
    s_nop 1
    v_cndmask_b32_e64 v194, v194, v4, vcc
    v_cmp_le_i32 vcc, 3, v6
    s_nop 1
    v_cndmask_b32_e64 v195, v195, v4, vcc
    v_cmp_le_i32 vcc, 8, v6
    s_nop 1
    v_cndmask_b32_e64 v196, v196, v4, vcc
    v_cmp_le_i32 vcc, 9, v6
    s_nop 1
    v_cndmask_b32_e64 v197, v197, v4, vcc
    v_cmp_le_i32 vcc, 10, v6
    s_nop 1
    v_cndmask_b32_e64 v198, v198, v4, vcc
    v_cmp_le_i32 vcc, 11, v6
    s_nop 1
    v_cndmask_b32_e64 v199, v199, v4, vcc
    v_cmp_le_i32 vcc, 16, v6
    s_nop 1
    v_cndmask_b32_e64 v200, v200, v4, vcc
    v_cmp_le_i32 vcc, 17, v6
    s_nop 1
    v_cndmask_b32_e64 v201, v201, v4, vcc
    v_cmp_le_i32 vcc, 18, v6
    s_nop 1
    v_cndmask_b32_e64 v202, v202, v4, vcc
    v_cmp_le_i32 vcc, 19, v6
    s_nop 1
    v_cndmask_b32_e64 v203, v203, v4, vcc
    v_cmp_le_i32 vcc, 24, v6
    s_nop 1
    v_cndmask_b32_e64 v204, v204, v4, vcc
    v_cmp_le_i32 vcc, 25, v6
    s_nop 1
    v_cndmask_b32_e64 v205, v205, v4, vcc
    v_cmp_le_i32 vcc, 26, v6
    s_nop 1
    v_cndmask_b32_e64 v206, v206, v4, vcc
    v_cmp_le_i32 vcc, 27, v6
    s_nop 1
    v_cndmask_b32_e64 v207, v207, v4, vcc
Lskip_33:
    v_exp_f32 v192, v192
    v_exp_f32 v193, v193
    v_exp_f32 v194, v194
    v_exp_f32 v195, v195
    v_exp_f32 v196, v196
    v_exp_f32 v197, v197
    v_exp_f32 v198, v198
    v_exp_f32 v199, v199
    v_exp_f32 v200, v200
    v_exp_f32 v201, v201
    v_exp_f32 v202, v202
    v_exp_f32 v203, v203
    v_exp_f32 v204, v204
    v_exp_f32 v205, v205
    v_exp_f32 v206, v206
    v_exp_f32 v207, v207
    v_cvt_pk_bf16_f32 v240, v192, v193
    v_cvt_pk_bf16_f32 v241, v194, v195
    v_cvt_pk_bf16_f32 v242, v196, v197
    v_cvt_pk_bf16_f32 v243, v198, v199
    v_cvt_pk_bf16_f32 v244, v200, v201
    v_cvt_pk_bf16_f32 v245, v202, v203
    v_cvt_pk_bf16_f32 v246, v204, v205
    v_cvt_pk_bf16_f32 v247, v206, v207
    s_nop 1
    v_mfma_f32_32x32x16_bf16 v[224:239], v[80:83], v[240:243], v[224:239]
    v_mfma_f32_32x32x16_bf16 v[224:239], v[84:87], v[244:247], v[224:239]
    v_subrev_u32 v5, 8192, v5
    v_sub_u32 v49, v49, v50
    s_sub_u32 s50, s50, 1
    s_cmp_ge_i32 s50, s51
    s_cbranch_scc1 L_mx1
    s_nop 15
    v_rcp_f32 v24, v232
    s_branch L_attn_ok
L_codeend:
.section .rodata,"a"
.p2align 6
.amdhsa_kernel gated_mix__linear_kernel_hedgehog__sliding_block__prompt_kernel
  .amdhsa_next_free_vgpr 256
  .amdhsa_next_free_sgpr 102
  .amdhsa_accum_offset 256
  .amdhsa_group_segment_fixed_size 0
  .amdhsa_kernarg_size 88
  .amdhsa_user_sgpr_count 2
  .amdhsa_user_sgpr_kernarg_segment_ptr 1
  .amdhsa_system_sgpr_workgroup_id_x 1
.end_amdhsa_kernel
```
